```python
import torch

def _softmax(x, axis=-1):
    return torch.softmax(x, dim=axis)

def _gelu(x):
    return torch.nn.functional.gelu(x, approximate='tanh')

def _silu(x):
    return torch.nn.functional.silu(x)

def _sigmoid(x):
    return torch.sigmoid(x)

def _layernorm(x, axis=-1, eps=1e-05):
    m = x.mean(dim=axis, keepdim=True)
    v = x.var(dim=axis, keepdim=True, unbiased=False)
    return (x - m) / torch.sqrt(v + eps)

def _scatter_add(tgt, idx, src, axis=0):
    return tgt.clone().index_add_(axis, idx, src)

def _segment_sum(src, seg, n):
    out = torch.zeros((n,) + src.shape[1:], dtype=src.dtype)
    return out.index_add_(0, seg, src)

def _pad(x, pw):
    flat = tuple((v for pair in reversed(pw) for v in pair))
    return torch.nn.functional.pad(x, flat)
kernel_name = 'adaLN_cond__sliding_local_dilated__glu_gated_geglu__prompt'

def setup_inputs():

    _w = lambda a: (lambda t: t.to(torch.bfloat16) if t.is_floating_point() else t)(torch.as_tensor(a))

    def _A_setup():
        B, S, D = (1, 2048, 448)
        return {'x': _w((lambda *s: torch.randn(*s, dtype=torch.bfloat16) * 0.05)(B, S, D)), 'wqkv': _w((lambda *s: torch.randn(*s, dtype=torch.bfloat16) * 0.05)(D, 3 * D)), 'wo': _w((lambda *s: torch.randn(*s, dtype=torch.bfloat16) * 0.05)(D, D))}
    _A_in = _A_setup()

    def _B_setup():
        B, S, Dm, Df = (1, 2048, 448, 1792)
        return {'x': _w((lambda *s: torch.randn(*s, dtype=torch.bfloat16) * 0.05)(B, S, Dm)), 'w_gate': _w((lambda *s: torch.randn(*s, dtype=torch.bfloat16) * 0.8)(Dm, Df) * Dm ** (-0.5)), 'w_up': _w((lambda *s: torch.randn(*s, dtype=torch.bfloat16) * 0.8)(Dm, Df) * Dm ** (-0.5)), 'w_down': _w((lambda *s: torch.randn(*s, dtype=torch.bfloat16) * 0.8)(Df, Dm) * Df ** (-0.5))}
    _B_in = _B_setup()
    return {'A_x': _A_in['x'], 'A_wqkv': _A_in['wqkv'], 'A_wo': _A_in['wo'], 'B_x': _B_in['x'], 'B_w_gate': _B_in['w_gate'], 'B_w_up': _B_in['w_up'], 'B_w_down': _B_in['w_down'], 'c': _w((lambda *s: torch.randn(*s, dtype=torch.bfloat16) * 0.1)(1, 448) * 8.0), 'w_mod': _w((lambda *s: torch.randn(*s, dtype=torch.bfloat16) * 0.1)(448, 6 * 448) * 448 ** (-0.5) * 8.0)}

def reference(A_x, A_wqkv, A_wo, B_x, B_w_gate, B_w_up, B_w_down, c, w_mod):

    def _A_ref(x, wqkv, wo):
        B, S, D = x.shape
        H = 16
        Dh = D // H
        W, dil = (8, 2)
        qkv = (lambda x, *d: x.permute(*d))((x @ wqkv).reshape(B, S, 3, H, Dh), 2, 0, 3, 1, 4)
        q, k, v = (qkv[0], qkv[1], qkv[2])
        scale = Dh ** (-0.5)
        pos = torch.arange(S)
        off = torch.arange(W) * dil
        idx = pos[:, None] - off[None, :]
        mask = idx >= 0
        idx_c = torch.where(mask, idx, 0).reshape(-1)
        kg = k[:, :, idx_c, :].reshape(B, H, S, W, Dh)
        vg = v[:, :, idx_c, :].reshape(B, H, S, W, Dh)
        logits = torch.einsum('bhsd,bhswd->bhsw', q, kg) * scale
        logits = torch.where(mask[None, None, :, :], logits, -1000000000.0)
        attn = _softmax(logits, axis=-1)
        o = torch.einsum('bhsw,bhswd->bhsd', attn, vg)
        return (lambda x, *d: x.permute(*d))(o, 0, 2, 1, 3).reshape(B, S, D) @ wo

    def _B_ref(x, w_gate, w_up, w_down):
        g = torch.einsum('bsd,df->bsf', x, w_gate)
        u = torch.einsum('bsd,df->bsf', x, w_up)
        h = _gelu(g) * u
        return torch.einsum('bsf,fd->bsd', h, w_down)
    x = A_x
    mod = (_silu(c) @ w_mod).reshape(c.shape[0], 6, 1, -1)
    sa, ca, ga, sb, cb, gb = (mod[:, 0].clone(), mod[:, 1].clone(), mod[:, 2].clone(), mod[:, 3].clone(), mod[:, 4].clone(), mod[:, 5].clone())
    h = _layernorm(x, axis=-1) * (1 + ca) + sa
    x = x + ga * _A_ref(h, A_wqkv, A_wo)
    h = _layernorm(x, axis=-1) * (1 + cb) + sb
    x = x + gb * _B_ref(h, B_w_gate, B_w_up, B_w_down)
    return x
```

```asm
; @launch grid=(256,1,1) block=(512,1,1) lds=163840
.amdgcn_target "amdgcn-amd-amdhsa--gfx950"
.text
.p2align 8
.globl adaLN_cond__sliding_local_dilated__glu_gated_geglu__prompt_kernel
.type adaLN_cond__sliding_local_dilated__glu_gated_geglu__prompt_kernel,@function
adaLN_cond__sliding_local_dilated__glu_gated_geglu__prompt_kernel:
  s_getpc_b64 s[48:49]
  s_cmp_ge_u32 s2, 256
  s_cbranch_scc1 L_end
  s_load_dwordx2 s[4:5], s[0:1], 0
  s_load_dwordx2 s[32:33], s[0:1], 64
  s_load_dwordx2 s[8:9], s[0:1], 8
  s_load_dwordx2 s[28:29], s[0:1], 56
  s_load_dwordx2 s[44:45], s[0:1], 88
  s_load_dwordx2 s[40:41], s[0:1], 80
  s_and_b32 s48, s48, 0xffffff00
  s_mov_b32 s50, L_code_end-adaLN_cond__sliding_local_dilated__glu_gated_geglu__prompt_kernel
  s_mov_b32 s51, 0x20000
  s_lshl_b32 s88, s2, 4
  s_and_b32 s88, s88, 0x380
  v_lshlrev_b32 v12, 10, v0
  buffer_load_dword v255, v12, s[48:51], s88 offen
  v_lshrrev_b32 v12, 6, v0
  v_and_b32 v1, 63, v0
  v_readfirstlane_b32 s52, v12
  s_and_b32 s53, s2, 7
  s_lshr_b32 s54, s2, 3
  v_lshlrev_b32 v17, 7, v1
  s_mov_b32 s6, 1835008
  s_mov_b32 s7, 0x20000
  s_mov_b32 s34, 2408448
  s_mov_b32 s35, 0x20000
  s_mov_b32 s10, 1204224
  s_mov_b32 s11, 0x20000
  v_lshlrev_b32 v2, 4, v1
  s_and_b32 s57, s54, 15
  s_mov_b32 s30, 896
  s_mov_b32 s31, 0x20000
  v_mov_b32 v104, 0
  v_mov_b32 v107, 0
  s_cmp_ge_u32 s52, 4
  s_cbranch_scc1 L_t47
  s_cmp_ge_u32 s54, 16
  s_cbranch_scc1 L_trep
  s_lshl_b32 s91, s54, 4
  s_lshl_b32 s92, s52, 2
  s_add_u32 s91, s91, s92
  s_add_u32 s91, s91, 32
L_trow:
  v_subrev_u32 v21, 56, v1
  v_ashrrev_i32 v21, 31, v21
  v_not_b32 v20, v21
  v_and_b32 v20, 0x40000000, v20
  v_or_b32 v20, v20, v2
  s_lshl_b32 s88, s53, 8
  s_add_u32 s88, s88, s91
  s_sub_u32 s88, s88, 32
  s_max_i32 s88, s88, 0
  s_mul_i32 s88, s88, 896
  s_waitcnt lgkmcnt(0)
  buffer_load_dwordx4 v[24:27], v20, s[4:7], s88 offen offset:0
  buffer_load_dwordx4 v[28:31], v20, s[4:7], s88 offen offset:896
  buffer_load_dwordx4 v[32:35], v20, s[4:7], s88 offen offset:1792
  buffer_load_dwordx4 v[36:39], v20, s[4:7], s88 offen offset:2688
  s_branch L_t9
L_trep:
  s_mul_i32 s88, s57, 56
  s_and_b32 s88, s88, 0xfffffff0
  v_add_u32 v12, 0, v1
  v_mul_u32_u24 v13, 43691, v12
  v_lshrrev_b32 v13, 19, v13
  v_mul_u32_u24 v14, 12, v13
  v_sub_u32 v12, v12, v14
  v_mul_u32_u24 v24, 2688, v13
  v_lshrrev_b32 v13, 2, v12
  v_mul_u32_u24 v13, 896, v13
  v_and_b32 v12, 3, v12
  v_lshl_add_u32 v13, v12, 4, v13
  v_add3_u32 v24, v24, v13, s88
  v_add_u32 v12, 64, v1
  v_mul_u32_u24 v13, 43691, v12
  v_lshrrev_b32 v13, 19, v13
  v_mul_u32_u24 v14, 12, v13
  v_sub_u32 v12, v12, v14
  v_mul_u32_u24 v25, 2688, v13
  v_lshrrev_b32 v13, 2, v12
  v_mul_u32_u24 v13, 896, v13
  v_and_b32 v12, 3, v12
  v_lshl_add_u32 v13, v12, 4, v13
  v_add3_u32 v25, v25, v13, s88
  v_add_u32 v12, 128, v1
  v_mul_u32_u24 v13, 43691, v12
  v_lshrrev_b32 v13, 19, v13
  v_mul_u32_u24 v14, 12, v13
  v_sub_u32 v12, v12, v14
  v_mul_u32_u24 v26, 2688, v13
  v_lshrrev_b32 v13, 2, v12
  v_mul_u32_u24 v13, 896, v13
  v_and_b32 v12, 3, v12
  v_lshl_add_u32 v13, v12, 4, v13
  v_add3_u32 v26, v26, v13, s88
  s_lshl_b32 s84, s53, 2
  s_add_u32 s84, s84, s52
  s_mul_i32 s88, s84, 43008
  s_waitcnt lgkmcnt(0)
  buffer_load_dwordx4 v[28:31], v24, s[8:11], s88 offen
  buffer_load_dwordx4 v[32:35], v25, s[8:11], s88 offen
  buffer_load_dwordx4 v[36:39], v26, s[8:11], s88 offen
  s_branch L_t9
L_t47:
  s_cmp_ge_u32 s52, 6
  s_cbranch_scc1 L_t67
  s_cmp_ge_u32 s2, 14
  s_cbranch_scc1 L_te
  v_lshrrev_b32 v13, 3, v1
  v_mul_u32_u24 v12, 5376, v13
  v_and_b32 v13, 2, v13
  v_and_b32 v14, 7, v1
  v_xor_b32 v14, v14, v13
  v_lshl_add_u32 v107, v14, 4, v12
  v_xor_b32 v104, 64, v107
  s_and_b32 s88, s52, 1
  s_lshl_b32 s83, s2, 7
  s_mul_i32 s89, s88, 1204224
  s_add_u32 s83, s83, s89
  s_mul_i32 s85, s88, 29696
  s_add_u32 s85, s85, 0
  s_setprio 3
  s_waitcnt lgkmcnt(0)
  s_add_u32 m0, s85, 0
  s_nop 0
  buffer_load_dwordx4 v107, s[32:35], s83 offen lds
  s_add_u32 s83, s83, 43008
  s_add_u32 m0, s85, 1024
  s_nop 0
  buffer_load_dwordx4 v104, s[32:35], s83 offen lds
  s_add_u32 s83, s83, 43008
  s_add_u32 m0, s85, 2048
  s_nop 0
  buffer_load_dwordx4 v107, s[32:35], s83 offen lds
  s_add_u32 s83, s83, 43008
  s_add_u32 m0, s85, 3072
  s_nop 0
  buffer_load_dwordx4 v104, s[32:35], s83 offen lds
  s_add_u32 s83, s83, 43008
  s_add_u32 m0, s85, 4096
  s_nop 0
  buffer_load_dwordx4 v107, s[32:35], s83 offen lds
  s_add_u32 s83, s83, 43008
  s_add_u32 m0, s85, 5120
  s_nop 0
  buffer_load_dwordx4 v104, s[32:35], s83 offen lds
  s_add_u32 s83, s83, 43008
  s_add_u32 m0, s85, 6144
  s_nop 0
  buffer_load_dwordx4 v107, s[32:35], s83 offen lds
  s_add_u32 s83, s83, 43008
  s_add_u32 m0, s85, 7168
  s_nop 0
  buffer_load_dwordx4 v104, s[32:35], s83 offen lds
  s_add_u32 s83, s83, 43008
  s_add_u32 m0, s85, 8192
  s_nop 0
  buffer_load_dwordx4 v107, s[32:35], s83 offen lds
  s_add_u32 s83, s83, 43008
  s_add_u32 m0, s85, 9216
  s_nop 0
  buffer_load_dwordx4 v104, s[32:35], s83 offen lds
  s_add_u32 s83, s83, 43008
  s_add_u32 m0, s85, 10240
  s_nop 0
  buffer_load_dwordx4 v107, s[32:35], s83 offen lds
  s_add_u32 s83, s83, 43008
  s_add_u32 m0, s85, 11264
  s_nop 0
  buffer_load_dwordx4 v104, s[32:35], s83 offen lds
  s_add_u32 s83, s83, 43008
  s_branch L_t9
L_te:
  s_mov_b32 s46, 14876672
  s_mov_b32 s47, 0x20000
  s_mov_b32 s88, 344064
  s_mov_b32 s42, 256
  s_mov_b32 s43, 0x20000
  s_lshl_b32 s89, s53, 5
  s_mov_b64 exec, 1
  s_waitcnt lgkmcnt(0)
  buffer_load_dword v255, off, s[44:47], s88
  buffer_load_dword v255, off, s[40:43], s89
  s_mov_b64 exec, -1
  s_branch L_t9
L_t67:
  s_lshl_b32 s91, s54, 3
  s_lshl_b32 s92, s52, 2
  s_add_u32 s91, s91, s92
  s_sub_u32 s91, s91, 120
  s_and_b32 s88, s54, 30
  s_cmp_eq_u32 s88, 14
  s_cbranch_scc1 L_trow
  s_cmp_eq_u32 s52, 7
  s_cbranch_scc1 L_t7
  s_sub_u32 s88, s54, 2
  s_lshr_b32 s88, s88, 1
  s_bfe_u32 s89, s88, 0x10001
  s_mul_i32 s89, s89, 1204224
  s_and_b32 s90, s88, 1
  s_mul_i32 s90, s90, 344064
  s_add_u32 s89, s89, s90
  s_add_u32 s89, s89, 516096
  s_lshl_b32 s90, s2, 7
  s_and_b32 s90, s90, 0x780
  s_add_u32 s89, s89, s90
  s_cmp_ge_u32 s88, 4
  s_cbranch_scc1 L_t9
  v_mul_u32_u24 v12, 5376, v1
  s_waitcnt lgkmcnt(0)
  buffer_load_dword v255, v12, s[32:35], s89 offen
  s_branch L_t9
L_t7:
  s_waitcnt lgkmcnt(0)
  buffer_load_dwordx4 v[200:203], v2, s[28:31], 0 offen
L_t9:
  s_load_dwordx2 s[12:13], s[0:1], 16
  s_load_dwordx2 s[16:17], s[0:1], 32
  s_load_dwordx2 s[20:21], s[0:1], 40
  s_load_dwordx2 s[24:25], s[0:1], 48
  s_load_dwordx2 s[36:37], s[0:1], 72
  s_mul_i32 s56, s53, 36864
  s_mov_b32 s88, 76800
  v_and_b32 v12, 15, v0
  v_lshlrev_b32 v12, 2, v12
  v_add_u32 v12, s88, v12
  v_mov_b32 v13, 0
  ds_write_b32 v12, v13
  v_mov_b32 v18, s88
  s_mov_b32 s46, 14876672
  s_mov_b32 s47, 0x20000
  s_mov_b32 s42, 256
  s_mov_b32 s43, 0x20000
  v_mov_b32 v4, 1
  v_lshrrev_b32 v9, 5, v1
  v_bfe_u32 v10, v1, 2, 2
  v_and_b32 v11, 3, v1
  v_bfe_u32 v16, v1, 4, 1
  s_getreg_b32 s3, hwreg(HW_REG_XCC_ID)
  s_and_b32 s3, s3, 15
  s_add_u32 s3, s3, 1
  s_and_b32 s96, s52, 1
  s_lshl_b32 s87, s53, 5
  s_add_u32 s86, s87, s54
  s_and_b32 s88, s54, 30
  s_cmp_eq_u32 s88, 14
  s_cselect_b32 s89, 0xcf, 0x0f
  s_cmp_lt_u32 s54, 16
  s_cselect_b32 s97, s89, 0
  s_waitcnt lgkmcnt(0)
  s_barrier
  s_buffer_load_dword s81, s[44:47], 344064
  s_lshl_b32 s88, s52, 5
  s_add_u32 s88, s88, s54
  s_cmp_eq_u32 s88, 143
  s_cbranch_scc1 L_zero
  s_cmp_eq_u32 s54, 15
  s_cselect_b32 s88, 1, s52
  s_cmp_lg_u32 s88, 7
  s_cbranch_scc1 L_r1
  v_mov_b32 v15, s3
  s_mov_b64 exec, 1
  buffer_store_byte v15, off, s[40:43], s86
  s_mov_b64 exec, -1
L_r1:
  s_bitcmp1_b32 s97, s52
  s_cbranch_scc1 L_rows
  s_cmp_lt_u32 s54, 16
  s_cbranch_scc1 L_chain
  s_cmp_ge_u32 s53, 7
  s_cbranch_scc1 L_fdisp
  s_cmp_ge_u32 s52, 4
  s_cbranch_scc1 L_fdisp
  s_mul_i32 s89, s57, 86016
  s_mul_i32 s90, s84, 3072
  s_add_u32 s89, s89, s90
  s_add_u32 s89, s89, 13500416
  s_lshl_b32 s91, s57, 7
  s_lshl_b32 s90, s53, 2
  s_add_u32 s91, s91, s90
  s_add_u32 s91, s91, 339968
  s_waitcnt vmcnt(0)
  buffer_store_dwordx4 v[28:31], v2, s[44:47], s89 offen offset:0 sc1
  buffer_store_dwordx4 v[32:35], v2, s[44:47], s89 offen offset:1024 sc1
  buffer_store_dwordx4 v[36:39], v2, s[44:47], s89 offen offset:2048 sc1
  s_waitcnt lgkmcnt(0)
  s_mul_i32 s88, s81, 0x9E3779B1
  s_add_u32 s88, s88, 0x7F4A7C15
  v_mov_b32 v15, s88
  s_waitcnt vmcnt(0)
  s_mov_b64 exec, 1
  ds_add_rtn_u32 v14, v18, v4 offset:20
  s_waitcnt lgkmcnt(0)
  v_cmp_ne_u32 vcc, 3, v14
  s_nop 0
  s_cbranch_vccnz L_nfw
  buffer_store_dword v15, off, s[44:47], s91 sc1
  ds_write_b32 v18, v4 offset:24
L_nfw:
  s_mov_b64 exec, -1
L_fdisp:
  s_cmp_lt_u32 s52, 4
  s_cbranch_scc1 L_fmain
  s_cmp_lt_u32 s52, 6
  s_cbranch_scc1 L_fj
  s_cmp_eq_u32 s52, 6
  s_cbranch_scc1 L_c67
  s_cmp_ge_u32 s53, 7
  s_cbranch_scc1 L_bg
  s_mov_b32 s99, 1048576
adaLN_cond__sliding_local_dilated__glu_gated_geglu__prompt_kernel_p1:
  ds_read_b32 v8, v18 offset:24
  s_waitcnt lgkmcnt(0)
  v_cmp_gt_u32 vcc, 1, v8
  s_sub_u32 s99, s99, 1
  s_cbranch_scc1 adaLN_cond__sliding_local_dilated__glu_gated_geglu__prompt_kernel_d2
  s_cbranch_vccnz adaLN_cond__sliding_local_dilated__glu_gated_geglu__prompt_kernel_p1
adaLN_cond__sliding_local_dilated__glu_gated_geglu__prompt_kernel_d2:
L_bg:
  s_mul_i32 s88, s57, 16128
  s_add_u32 s88, s88, 393216
  s_mul_i32 s89, s53, 258048
  s_add_u32 s88, s88, s89
  buffer_load_dword v255, v17, s[44:47], s88 offen
  s_add_u32 s88, s88, 8192
  s_mov_b32 exec_lo, 4294967295
  s_mov_b32 exec_hi, 1073741823
  buffer_load_dword v255, v17, s[44:47], s88 offen
  s_mov_b64 exec, -1
  s_branch L_h67m
L_chain:
  s_lshl_b32 s84, s54, 3
  s_add_u32 s84, s84, s53
  s_lshl_b32 s88, s54, 2
  s_add_u32 s88, s88, s53
  s_add_u32 s88, s88, 6
  s_cmp_lt_u32 s53, 4
  s_cselect_b32 s88, s88, 99
  s_cmp_lt_u32 s88, 14
  s_cselect_b32 s88, 99, s88
  s_cmp_lt_u32 s84, 14
  s_cselect_b32 s84, s84, s88
  s_cmp_eq_u32 s52, 6
  s_cbranch_scc1 L_c67
  s_cmp_ge_u32 s84, 42
  s_cbranch_scc1 L_ngv0
  s_cmp_eq_u32 s52, 7
  s_cbranch_scc1 L_sil
  s_cmp_lt_u32 s84, 14
  s_cbranch_scc1 L_gva
  s_mov_b32 s99, 1048576
adaLN_cond__sliding_local_dilated__glu_gated_geglu__prompt_kernel_p3:
  ds_read_b32 v8, v18 offset:28
  s_waitcnt lgkmcnt(0)
  v_cmp_gt_u32 vcc, 1, v8
  s_nop 0
  s_cbranch_vccz adaLN_cond__sliding_local_dilated__glu_gated_geglu__prompt_kernel_d4
  s_sleep 1
  s_sub_u32 s99, s99, 1
  s_cbranch_scc1 adaLN_cond__sliding_local_dilated__glu_gated_geglu__prompt_kernel_d4
  s_cbranch_vccnz adaLN_cond__sliding_local_dilated__glu_gated_geglu__prompt_kernel_p3
adaLN_cond__sliding_local_dilated__glu_gated_geglu__prompt_kernel_d4:
  v_lshrrev_b32 v13, 3, v1
  v_mul_u32_u24 v12, 5376, v13
  v_and_b32 v13, 2, v13
  v_and_b32 v14, 7, v1
  v_xor_b32 v14, v14, v13
  v_lshl_add_u32 v107, v14, 4, v12
  v_xor_b32 v104, 64, v107
  s_and_b32 s88, s52, 1
  s_lshl_b32 s83, s84, 7
  s_mul_i32 s89, s88, 1204224
  s_add_u32 s83, s83, s89
  s_mul_i32 s85, s88, 29696
  s_add_u32 s85, s85, 0
  s_setprio 3
  s_waitcnt lgkmcnt(0)
  s_add_u32 m0, s85, 0
  s_nop 0
  buffer_load_dwordx4 v107, s[32:35], s83 offen lds
  s_add_u32 s83, s83, 43008
  s_add_u32 m0, s85, 1024
  s_nop 0
  buffer_load_dwordx4 v104, s[32:35], s83 offen lds
  s_add_u32 s83, s83, 43008
  s_add_u32 m0, s85, 2048
  s_nop 0
  buffer_load_dwordx4 v107, s[32:35], s83 offen lds
  s_add_u32 s83, s83, 43008
  s_add_u32 m0, s85, 3072
  s_nop 0
  buffer_load_dwordx4 v104, s[32:35], s83 offen lds
  s_add_u32 s83, s83, 43008
  s_add_u32 m0, s85, 4096
  s_nop 0
  buffer_load_dwordx4 v107, s[32:35], s83 offen lds
  s_add_u32 s83, s83, 43008
  s_add_u32 m0, s85, 5120
  s_nop 0
  buffer_load_dwordx4 v104, s[32:35], s83 offen lds
  s_add_u32 s83, s83, 43008
  s_add_u32 m0, s85, 6144
  s_nop 0
  buffer_load_dwordx4 v107, s[32:35], s83 offen lds
  s_add_u32 s83, s83, 43008
  s_add_u32 m0, s85, 7168
  s_nop 0
  buffer_load_dwordx4 v104, s[32:35], s83 offen lds
  s_add_u32 s83, s83, 43008
  s_add_u32 m0, s85, 8192
  s_nop 0
  buffer_load_dwordx4 v107, s[32:35], s83 offen lds
  s_add_u32 s83, s83, 43008
  s_add_u32 m0, s85, 9216
  s_nop 0
  buffer_load_dwordx4 v104, s[32:35], s83 offen lds
  s_add_u32 s83, s83, 43008
  s_add_u32 m0, s85, 10240
  s_nop 0
  buffer_load_dwordx4 v107, s[32:35], s83 offen lds
  s_add_u32 s83, s83, 43008
  s_add_u32 m0, s85, 11264
  s_nop 0
  buffer_load_dwordx4 v104, s[32:35], s83 offen lds
  s_add_u32 s83, s83, 43008
L_gva:
  v_lshrrev_b32 v15, 4, v1
  v_lshl_add_u32 v13, v15, 3, v10
  v_lshlrev_b32 v108, 7, v13
  v_lshl_add_u32 v108, v11, 3, v108
  v_add_u32 v108, s85, v108
  v_lshrrev_b32 v13, 1, v10
  v_lshl_add_u32 v13, v16, 1, v13
  v_lshl_add_u32 v108, v13, 5, v108
  v_xor_b32 v109, 32, v108
  v_xor_b32 v105, 64, v108
  v_xor_b32 v106, 96, v108
  s_mul_i32 s89, s96, 448
  s_add_u32 s89, s89, 28672
  v_lshlrev_b32 v110, 4, v15
  v_add_u32 v110, s89, v110
  s_mul_i32 s89, s84, 37
  s_lshr_b32 s89, s89, 8
  s_mul_i32 s90, s89, 7
  s_sub_u32 s90, s84, s90
  s_lshl_b32 s90, s90, 7
  s_mul_i32 s91, s89, 1792
  s_add_u32 s90, s90, s91
  s_add_u32 s90, s90, 327680
  s_cmp_eq_u32 s89, 1
  s_cselect_b32 s91, 1.0, 0
  s_cmp_eq_u32 s89, 4
  s_cselect_b32 s91, 1.0, s91
  v_and_b32 v14, 1, v10
  v_mul_u32_u24 v14, 896, v14
  v_lshrrev_b32 v15, 3, v1
  v_lshl_add_u32 v14, v15, 4, v14
  v_lshl_add_u32 v14, v11, 2, v14
  v_lshl_add_u32 v15, v1, 2, v18
  s_add_u32 m0, s85, 12288
  s_nop 0
  buffer_load_dwordx4 v107, s[32:35], s83 offen lds
  s_add_u32 s83, s83, 43008
  s_add_u32 m0, s85, 13312
  s_nop 0
  buffer_load_dwordx4 v104, s[32:35], s83 offen lds
  s_add_u32 s83, s83, 43008
  s_add_u32 m0, s85, 14336
  s_nop 0
  buffer_load_dwordx4 v107, s[32:35], s83 offen lds
  s_add_u32 s83, s83, 43008
  s_add_u32 m0, s85, 15360
  s_nop 0
  buffer_load_dwordx4 v104, s[32:35], s83 offen lds
  s_add_u32 s83, s83, 43008
  s_add_u32 m0, s85, 16384
  s_nop 0
  buffer_load_dwordx4 v107, s[32:35], s83 offen lds
  s_add_u32 s83, s83, 43008
  s_add_u32 m0, s85, 17408
  s_nop 0
  buffer_load_dwordx4 v104, s[32:35], s83 offen lds
  s_add_u32 s83, s83, 43008
  s_add_u32 m0, s85, 18432
  s_nop 0
  buffer_load_dwordx4 v107, s[32:35], s83 offen lds
  s_add_u32 s83, s83, 43008
  s_add_u32 m0, s85, 19456
  s_nop 0
  buffer_load_dwordx4 v104, s[32:35], s83 offen lds
  s_add_u32 s83, s83, 43008
  s_add_u32 m0, s85, 20480
  s_nop 0
  buffer_load_dwordx4 v107, s[32:35], s83 offen lds
  s_add_u32 s83, s83, 43008
  s_add_u32 m0, s85, 21504
  s_nop 0
  buffer_load_dwordx4 v104, s[32:35], s83 offen lds
  s_add_u32 s83, s83, 43008
  s_add_u32 m0, s85, 22528
  s_nop 0
  buffer_load_dwordx4 v107, s[32:35], s83 offen lds
  s_add_u32 s83, s83, 43008
  s_add_u32 m0, s85, 23552
  s_nop 0
  buffer_load_dwordx4 v104, s[32:35], s83 offen lds
  s_add_u32 s83, s83, 43008
  s_add_u32 m0, s85, 24576
  s_nop 0
  buffer_load_dwordx4 v107, s[32:35], s83 offen lds
  s_add_u32 s83, s83, 43008
  s_add_u32 m0, s85, 25600
  s_nop 0
  buffer_load_dwordx4 v104, s[32:35], s83 offen lds
  s_add_u32 s83, s83, 43008
  s_add_u32 m0, s85, 26624
  s_nop 0
  buffer_load_dwordx4 v107, s[32:35], s83 offen lds
  s_add_u32 s83, s83, 43008
  s_add_u32 m0, s85, 27648
  s_nop 0
  buffer_load_dwordx4 v104, s[32:35], s83 offen lds
  s_add_u32 s83, s83, 43008
  s_waitcnt lgkmcnt(0)
  s_mul_i32 s81, s81, 0x9E3779B1
  s_add_u32 s81, s81, 0x7F4A7C15
  s_and_b32 s2, s81, 0xffff
  s_mov_b32 s14, 401408
  s_mov_b32 s15, 0x20000
  s_mov_b32 s18, 1605632
  s_mov_b32 s19, 0x20000
  s_mov_b32 s22, 1605632
  s_mov_b32 s23, 0x20000
  s_mov_b32 s26, 1605632
  s_mov_b32 s27, 0x20000
  s_mov_b32 s38, 1835008
  s_mov_b32 s39, 0x20000
  s_sub_u32 s50, 31, s54
  s_mul_i32 s98, s53, 7
  s_lshr_b32 s98, s98, 1
  s_add_u32 s51, s50, s98
  s_sub_u32 s98, s51, 28
  s_cmp_ge_u32 s51, 28
  s_cselect_b32 s51, s98, s51
  s_lshr_b32 s58, s54, 4
  s_lshl_b32 s58, s58, 2
  s_add_u32 s58, s58, 1
  s_mul_i32 s59, s50, 37
  s_lshr_b32 s59, s59, 8
  s_mul_i32 s60, s59, 7
  s_sub_u32 s60, s50, s60
  s_mul_i32 s61, s53, 258048
  s_add_u32 s61, s61, 393216
  s_and_b32 s98, s52, 1
  s_lshl_b32 s99, s59, 1
  s_add_u32 s62, s98, s99
  s_lshr_b32 s63, s52, 1
  s_sub_u32 s82, s50, 16
  s_cmp_ge_i32 s82, 7
  s_cselect_b32 s98, 7, 0
  s_cselect_b32 s83, 4, 0
  s_sub_u32 s82, s82, s98
  s_max_i32 s82, s82, 0
  s_min_i32 s82, s82, 6
  s_and_b32 s98, s52, 3
  s_add_u32 s83, s83, s98
  s_mov_b32 s99, 1048576
adaLN_cond__sliding_local_dilated__glu_gated_geglu__prompt_kernel_p5:
  ds_read_b32 v8, v18 offset:28
  s_waitcnt lgkmcnt(0)
  v_cmp_gt_u32 vcc, 1, v8
  s_sub_u32 s99, s99, 1
  s_cbranch_scc1 adaLN_cond__sliding_local_dilated__glu_gated_geglu__prompt_kernel_d6
  s_cbranch_vccnz adaLN_cond__sliding_local_dilated__glu_gated_geglu__prompt_kernel_p5
adaLN_cond__sliding_local_dilated__glu_gated_geglu__prompt_kernel_d6:
  ds_read_b128 v[24:27], v110 offset:0
  ds_read_b128 v[28:31], v110 offset:64
  ds_read_b128 v[32:35], v110 offset:128
  ds_read_b128 v[36:39], v110 offset:192
  ds_read_b128 v[40:43], v110 offset:256
  ds_read_b128 v[44:47], v110 offset:320
  ds_read_b128 v[48:51], v110 offset:384
  s_waitcnt vmcnt(24)
  ds_read_b64_tr_b16 v[144:145], v108 offset:0
  ds_read_b64_tr_b16 v[146:147], v108 offset:512
  ds_read_b64_tr_b16 v[148:149], v109 offset:0
  ds_read_b64_tr_b16 v[150:151], v109 offset:512
  ds_read_b64_tr_b16 v[152:153], v105 offset:0
  ds_read_b64_tr_b16 v[154:155], v105 offset:512
  ds_read_b64_tr_b16 v[156:157], v106 offset:0
  ds_read_b64_tr_b16 v[158:159], v106 offset:512
  s_waitcnt vmcnt(20)
  ds_read_b64_tr_b16 v[160:161], v108 offset:4096
  ds_read_b64_tr_b16 v[162:163], v108 offset:4608
  ds_read_b64_tr_b16 v[164:165], v109 offset:4096
  ds_read_b64_tr_b16 v[166:167], v109 offset:4608
  ds_read_b64_tr_b16 v[168:169], v105 offset:4096
  ds_read_b64_tr_b16 v[170:171], v105 offset:4608
  ds_read_b64_tr_b16 v[172:173], v106 offset:4096
  ds_read_b64_tr_b16 v[174:175], v106 offset:4608
  s_waitcnt lgkmcnt(14)
  v_mfma_f32_16x16x32_bf16 v[112:115], v[24:27], v[144:147], 0
  s_waitcnt lgkmcnt(12)
  v_mfma_f32_16x16x32_bf16 v[116:119], v[24:27], v[148:151], 0
  s_waitcnt lgkmcnt(10)
  v_mfma_f32_16x16x32_bf16 v[120:123], v[24:27], v[152:155], 0
  s_waitcnt lgkmcnt(8)
  v_mfma_f32_16x16x32_bf16 v[124:127], v[24:27], v[156:159], 0
  s_waitcnt vmcnt(16)
  ds_read_b64_tr_b16 v[176:177], v108 offset:8192
  ds_read_b64_tr_b16 v[178:179], v108 offset:8704
  ds_read_b64_tr_b16 v[180:181], v109 offset:8192
  ds_read_b64_tr_b16 v[182:183], v109 offset:8704
  ds_read_b64_tr_b16 v[184:185], v105 offset:8192
  ds_read_b64_tr_b16 v[186:187], v105 offset:8704
  ds_read_b64_tr_b16 v[188:189], v106 offset:8192
  ds_read_b64_tr_b16 v[190:191], v106 offset:8704
  s_waitcnt lgkmcnt(14)
  v_mfma_f32_16x16x32_bf16 v[112:115], v[28:31], v[160:163], v[112:115]
  s_waitcnt lgkmcnt(12)
  v_mfma_f32_16x16x32_bf16 v[116:119], v[28:31], v[164:167], v[116:119]
  s_waitcnt lgkmcnt(10)
  v_mfma_f32_16x16x32_bf16 v[120:123], v[28:31], v[168:171], v[120:123]
  s_waitcnt lgkmcnt(8)
  v_mfma_f32_16x16x32_bf16 v[124:127], v[28:31], v[172:175], v[124:127]
  s_waitcnt vmcnt(12)
  ds_read_b64_tr_b16 v[192:193], v108 offset:12288
  ds_read_b64_tr_b16 v[194:195], v108 offset:12800
  ds_read_b64_tr_b16 v[196:197], v109 offset:12288
  ds_read_b64_tr_b16 v[198:199], v109 offset:12800
  ds_read_b64_tr_b16 v[212:213], v105 offset:12288
  ds_read_b64_tr_b16 v[214:215], v105 offset:12800
  ds_read_b64_tr_b16 v[216:217], v106 offset:12288
  ds_read_b64_tr_b16 v[218:219], v106 offset:12800
  s_waitcnt lgkmcnt(14)
  v_mfma_f32_16x16x32_bf16 v[112:115], v[32:35], v[176:179], v[112:115]
  s_waitcnt lgkmcnt(12)
  v_mfma_f32_16x16x32_bf16 v[116:119], v[32:35], v[180:183], v[116:119]
  s_waitcnt lgkmcnt(10)
  v_mfma_f32_16x16x32_bf16 v[120:123], v[32:35], v[184:187], v[120:123]
  s_waitcnt lgkmcnt(8)
  v_mfma_f32_16x16x32_bf16 v[124:127], v[32:35], v[188:191], v[124:127]
  s_waitcnt vmcnt(8)
  ds_read_b64_tr_b16 v[220:221], v108 offset:16384
  ds_read_b64_tr_b16 v[222:223], v108 offset:16896
  ds_read_b64_tr_b16 v[224:225], v109 offset:16384
  ds_read_b64_tr_b16 v[226:227], v109 offset:16896
  ds_read_b64_tr_b16 v[228:229], v105 offset:16384
  ds_read_b64_tr_b16 v[230:231], v105 offset:16896
  ds_read_b64_tr_b16 v[232:233], v106 offset:16384
  ds_read_b64_tr_b16 v[234:235], v106 offset:16896
  s_waitcnt lgkmcnt(14)
  v_mfma_f32_16x16x32_bf16 v[112:115], v[36:39], v[192:195], v[112:115]
  s_waitcnt lgkmcnt(12)
  v_mfma_f32_16x16x32_bf16 v[116:119], v[36:39], v[196:199], v[116:119]
  s_waitcnt lgkmcnt(10)
  v_mfma_f32_16x16x32_bf16 v[120:123], v[36:39], v[212:215], v[120:123]
  s_waitcnt lgkmcnt(8)
  v_mfma_f32_16x16x32_bf16 v[124:127], v[36:39], v[216:219], v[124:127]
  s_waitcnt vmcnt(4)
  ds_read_b64_tr_b16 v[236:237], v108 offset:20480
  ds_read_b64_tr_b16 v[238:239], v108 offset:20992
  ds_read_b64_tr_b16 v[240:241], v109 offset:20480
  ds_read_b64_tr_b16 v[242:243], v109 offset:20992
  ds_read_b64_tr_b16 v[80:81], v105 offset:20480
  ds_read_b64_tr_b16 v[82:83], v105 offset:20992
  ds_read_b64_tr_b16 v[84:85], v106 offset:20480
  ds_read_b64_tr_b16 v[86:87], v106 offset:20992
  s_waitcnt lgkmcnt(14)
  v_mfma_f32_16x16x32_bf16 v[112:115], v[40:43], v[220:223], v[112:115]
  s_waitcnt lgkmcnt(12)
  v_mfma_f32_16x16x32_bf16 v[116:119], v[40:43], v[224:227], v[116:119]
  s_waitcnt lgkmcnt(10)
  v_mfma_f32_16x16x32_bf16 v[120:123], v[40:43], v[228:231], v[120:123]
  s_waitcnt lgkmcnt(8)
  v_mfma_f32_16x16x32_bf16 v[124:127], v[40:43], v[232:235], v[124:127]
  s_waitcnt vmcnt(0)
  ds_read_b64_tr_b16 v[88:89], v108 offset:24576
  ds_read_b64_tr_b16 v[90:91], v108 offset:25088
  ds_read_b64_tr_b16 v[92:93], v109 offset:24576
  ds_read_b64_tr_b16 v[94:95], v109 offset:25088
  ds_read_b64_tr_b16 v[96:97], v105 offset:24576
  ds_read_b64_tr_b16 v[98:99], v105 offset:25088
  ds_read_b64_tr_b16 v[100:101], v106 offset:24576
  ds_read_b64_tr_b16 v[102:103], v106 offset:25088
  s_waitcnt lgkmcnt(14)
  v_mfma_f32_16x16x32_bf16 v[112:115], v[44:47], v[236:239], v[112:115]
  s_waitcnt lgkmcnt(12)
  v_mfma_f32_16x16x32_bf16 v[116:119], v[44:47], v[240:243], v[116:119]
  s_waitcnt lgkmcnt(10)
  v_mfma_f32_16x16x32_bf16 v[120:123], v[44:47], v[80:83], v[120:123]
  s_waitcnt lgkmcnt(8)
  v_mfma_f32_16x16x32_bf16 v[124:127], v[44:47], v[84:87], v[124:127]
  s_waitcnt lgkmcnt(6)
  v_mfma_f32_16x16x32_bf16 v[112:115], v[48:51], v[88:91], v[112:115]
  s_waitcnt lgkmcnt(4)
  v_mfma_f32_16x16x32_bf16 v[116:119], v[48:51], v[92:95], v[116:119]
  s_waitcnt lgkmcnt(2)
  v_mfma_f32_16x16x32_bf16 v[120:123], v[48:51], v[96:99], v[120:123]
  s_waitcnt lgkmcnt(0)
  v_mfma_f32_16x16x32_bf16 v[124:127], v[48:51], v[100:103], v[124:127]
  s_mov_b32 vcc_lo, 0xffff0000
  s_mov_b32 vcc_hi, 0xffff0000
  s_mov_b32 s88, 0
  s_mov_b32 s89, -1
  v_cndmask_b32 v112, v112, v116, vcc
  s_nop 2
  v_cndmask_b32 v120, v120, v124, vcc
  v_cndmask_b32_e64 v112, v112, v120, s[88:89]
  s_cmp_lg_u32 s96, 0
  s_cbranch_scc1 L_gv5
  s_mov_b32 s99, 1048576
adaLN_cond__sliding_local_dilated__glu_gated_geglu__prompt_kernel_p7:
  ds_read_b32 v8, v18 offset:16
  ds_read_b32 v113, v15 offset:64
  s_waitcnt lgkmcnt(0)
  v_cmp_eq_u32 vcc, 0, v8
  s_sub_u32 s99, s99, 1
  s_cbranch_scc1 adaLN_cond__sliding_local_dilated__glu_gated_geglu__prompt_kernel_d8
  s_cbranch_vccnz adaLN_cond__sliding_local_dilated__glu_gated_geglu__prompt_kernel_p7
adaLN_cond__sliding_local_dilated__glu_gated_geglu__prompt_kernel_d8:
  v_add_f32 v112, v112, v113
  v_cvt_pk_bf16_f32 v112, v112, v112
  v_and_b32 v112, 0xffff0000, v112
  v_add_f32 v112, s91, v112
  v_cvt_pk_bf16_f32 v112, v112, v112
  v_and_b32 v112, 0xffff0000, v112
  v_or_b32 v112, s2, v112
  buffer_store_dword v112, v14, s[44:47], s90 offen sc1
  s_cmp_lg_u32 s54, 0
  s_cbranch_scc1 L_nogv2
  s_add_u32 s88, s56, 1280
  s_mov_b32 s99, 1048576
adaLN_cond__sliding_local_dilated__glu_gated_geglu__prompt_kernel_p9:
  ds_read_b32 v8, v18 offset:0
  s_waitcnt lgkmcnt(0)
  v_cmp_gt_u32 vcc, 1, v8
  s_sub_u32 s99, s99, 1
  s_cbranch_scc1 adaLN_cond__sliding_local_dilated__glu_gated_geglu__prompt_kernel_d10
  s_cbranch_vccnz adaLN_cond__sliding_local_dilated__glu_gated_geglu__prompt_kernel_p9
adaLN_cond__sliding_local_dilated__glu_gated_geglu__prompt_kernel_d10:
  v_readfirstlane_b32 s55, v8
  s_nop 0
  s_sub_u32 s55, s55, 1
  s_cmp_lg_u32 s55, 0
  s_cbranch_scc1 adaLN_cond__sliding_local_dilated__glu_gated_geglu__prompt_kernel_m11
  s_waitcnt vmcnt(0)
  s_mov_b64 exec, 1
  buffer_store_dword v4, off, s[44:47], s88
  s_mov_b64 exec, -1
adaLN_cond__sliding_local_dilated__glu_gated_geglu__prompt_kernel_e12:
  s_branch L_nogv2
L_gv5:
  ds_write_b32 v15, v112 offset:64
  ds_write_b32 v18, v4 offset:16
  s_branch L_nogv2
L_sil:
  s_waitcnt vmcnt(1)
  s_setprio 3
  v_add_u32 v13, 28672, v2
  v_lshlrev_b32 v204, 16, v200
  v_and_b32 v205, 0xffff0000, v200
  v_lshlrev_b32 v206, 16, v201
  v_and_b32 v207, 0xffff0000, v201
  v_lshlrev_b32 v208, 16, v202
  v_and_b32 v209, 0xffff0000, v202
  v_lshlrev_b32 v210, 16, v203
  v_and_b32 v211, 0xffff0000, v203
  v_mul_f32 v112, 0xbfb8aa3b, v204
  v_mul_f32 v113, 0xbfb8aa3b, v205
  v_mul_f32 v114, 0xbfb8aa3b, v206
  v_mul_f32 v115, 0xbfb8aa3b, v207
  v_mul_f32 v116, 0xbfb8aa3b, v208
  v_mul_f32 v117, 0xbfb8aa3b, v209
  v_mul_f32 v118, 0xbfb8aa3b, v210
  v_mul_f32 v119, 0xbfb8aa3b, v211
  v_exp_f32 v112, v112
  v_exp_f32 v113, v113
  v_exp_f32 v114, v114
  v_exp_f32 v115, v115
  v_exp_f32 v116, v116
  v_exp_f32 v117, v117
  v_exp_f32 v118, v118
  v_exp_f32 v119, v119
  v_add_f32 v112, 1.0, v112
  v_add_f32 v113, 1.0, v113
  v_add_f32 v114, 1.0, v114
  v_add_f32 v115, 1.0, v115
  v_add_f32 v116, 1.0, v116
  v_add_f32 v117, 1.0, v117
  v_add_f32 v118, 1.0, v118
  v_add_f32 v119, 1.0, v119
  v_rcp_f32 v112, v112
  v_rcp_f32 v113, v113
  v_rcp_f32 v114, v114
  v_rcp_f32 v115, v115
  v_rcp_f32 v116, v116
  v_rcp_f32 v117, v117
  v_rcp_f32 v118, v118
  v_rcp_f32 v119, v119
  v_mul_f32 v204, v204, v112
  v_mul_f32 v205, v205, v113
  v_mul_f32 v206, v206, v114
  v_mul_f32 v207, v207, v115
  v_mul_f32 v208, v208, v116
  v_mul_f32 v209, v209, v117
  v_mul_f32 v210, v210, v118
  v_mul_f32 v211, v211, v119
  v_cvt_pk_bf16_f32 v200, v204, v205
  v_cvt_pk_bf16_f32 v201, v206, v207
  v_cvt_pk_bf16_f32 v202, v208, v209
  v_cvt_pk_bf16_f32 v203, v210, v211
  ds_write_b128 v13, v[200:203]
  ds_write_b32 v18, v4 offset:28
  s_setprio 0
  s_branch L_h67m
L_ngv0:
  s_cmp_ge_u32 s54, 14
  s_cbranch_scc1 L_lead
  s_cmp_eq_u32 s52, 7
  s_cbranch_scc1 L_h67m
  s_branch L_nogv
L_lead:
  s_cmp_lg_u32 s96, 0
  s_cbranch_scc1 L_nogv
  s_branch L_lchk
L_zero:
  v_mov_b32 v12, 0
  v_mov_b32 v14, 0
  v_mov_b32 v15, 0
  buffer_store_dwordx4 v[12:15], v2, s[44:47], s56 offen offset:0 sc1
  buffer_store_dwordx4 v[12:15], v2, s[44:47], s56 offen offset:1024 sc1
  buffer_store_dwordx4 v[12:15], v2, s[44:47], s56 offen offset:2048 sc1
  buffer_store_dwordx4 v[12:15], v2, s[44:47], s56 offen offset:3072 sc1
  s_waitcnt vmcnt(0)
  s_nop 0
  v_mov_b32 v15, s3
  s_mov_b64 exec, 1
  buffer_store_byte v15, off, s[40:43], s86
  s_mov_b64 exec, -1
L_lchk:
  v_and_b32 v3, 31, v1
  s_mov_b32 s99, 64
adaLN_cond__sliding_local_dilated__glu_gated_geglu__prompt_kernel_cp13:
  buffer_load_ubyte v8, v3, s[40:43], s87 offen sc1
  s_waitcnt vmcnt(0)
  v_cmp_ne_u32 vcc, s3, v8
  s_mov_b32 s98, 1
  s_cbranch_vccnz adaLN_cond__sliding_local_dilated__glu_gated_geglu__prompt_kernel_sl14
adaLN_cond__sliding_local_dilated__glu_gated_geglu__prompt_kernel_wr17:
  v_mov_b32 v8, s98
  ds_write_b32 v18, v8
  s_branch L_nogv
L_c67:
  v_and_b32 v3, 31, v1
  s_mov_b32 s99, 64
adaLN_cond__sliding_local_dilated__glu_gated_geglu__prompt_kernel_cp18:
  buffer_load_ubyte v8, v3, s[40:43], s87 offen sc1
  s_waitcnt vmcnt(0)
  v_cmp_ne_u32 vcc, s3, v8
  s_mov_b32 s98, 1
  s_cbranch_vccnz adaLN_cond__sliding_local_dilated__glu_gated_geglu__prompt_kernel_sl19
adaLN_cond__sliding_local_dilated__glu_gated_geglu__prompt_kernel_wr22:
  v_mov_b32 v8, s98
  ds_write_b32 v18, v8
  s_branch L_h67m
L_rows:
  s_waitcnt vmcnt(0)
  v_lshlrev_b32 v40, 16, v24
  v_and_b32 v41, 0xffff0000, v24
  v_lshlrev_b32 v42, 16, v25
  v_and_b32 v43, 0xffff0000, v25
  v_lshlrev_b32 v44, 16, v26
  v_and_b32 v45, 0xffff0000, v26
  v_lshlrev_b32 v46, 16, v27
  v_and_b32 v47, 0xffff0000, v27
  v_pk_add_f32 v[72:73], v[40:41], v[42:43]
  v_pk_add_f32 v[74:75], v[44:45], v[46:47]
  v_pk_add_f32 v[72:73], v[72:73], v[74:75]
  v_add_f32 v88, v72, v73
  v_lshlrev_b32 v48, 16, v28
  v_and_b32 v49, 0xffff0000, v28
  v_lshlrev_b32 v50, 16, v29
  v_and_b32 v51, 0xffff0000, v29
  v_lshlrev_b32 v52, 16, v30
  v_and_b32 v53, 0xffff0000, v30
  v_lshlrev_b32 v54, 16, v31
  v_and_b32 v55, 0xffff0000, v31
  v_pk_add_f32 v[72:73], v[48:49], v[50:51]
  v_pk_add_f32 v[74:75], v[52:53], v[54:55]
  v_pk_add_f32 v[72:73], v[72:73], v[74:75]
  v_add_f32 v90, v72, v73
  v_lshlrev_b32 v56, 16, v32
  v_and_b32 v57, 0xffff0000, v32
  v_lshlrev_b32 v58, 16, v33
  v_and_b32 v59, 0xffff0000, v33
  v_lshlrev_b32 v60, 16, v34
  v_and_b32 v61, 0xffff0000, v34
  v_lshlrev_b32 v62, 16, v35
  v_and_b32 v63, 0xffff0000, v35
  v_pk_add_f32 v[72:73], v[56:57], v[58:59]
  v_pk_add_f32 v[74:75], v[60:61], v[62:63]
  v_pk_add_f32 v[72:73], v[72:73], v[74:75]
  v_add_f32 v92, v72, v73
  v_lshlrev_b32 v64, 16, v36
  v_and_b32 v65, 0xffff0000, v36
  v_lshlrev_b32 v66, 16, v37
  v_and_b32 v67, 0xffff0000, v37
  v_lshlrev_b32 v68, 16, v38
  v_and_b32 v69, 0xffff0000, v38
  v_lshlrev_b32 v70, 16, v39
  v_and_b32 v71, 0xffff0000, v39
  v_pk_add_f32 v[72:73], v[64:65], v[66:67]
  v_pk_add_f32 v[74:75], v[68:69], v[70:71]
  v_pk_add_f32 v[72:73], v[72:73], v[74:75]
  v_add_f32 v94, v72, v73
  v_add_f32_dpp v88, v88, v88 quad_perm:[1,0,3,2] row_mask:0xf bank_mask:0xf
  v_add_f32_dpp v90, v90, v90 quad_perm:[1,0,3,2] row_mask:0xf bank_mask:0xf
  v_add_f32_dpp v92, v92, v92 quad_perm:[1,0,3,2] row_mask:0xf bank_mask:0xf
  v_add_f32_dpp v94, v94, v94 quad_perm:[1,0,3,2] row_mask:0xf bank_mask:0xf
  v_add_f32_dpp v88, v88, v88 quad_perm:[2,3,0,1] row_mask:0xf bank_mask:0xf
  v_add_f32_dpp v90, v90, v90 quad_perm:[2,3,0,1] row_mask:0xf bank_mask:0xf
  v_add_f32_dpp v92, v92, v92 quad_perm:[2,3,0,1] row_mask:0xf bank_mask:0xf
  v_add_f32_dpp v94, v94, v94 quad_perm:[2,3,0,1] row_mask:0xf bank_mask:0xf
  v_add_f32_dpp v88, v88, v88 row_half_mirror row_mask:0xf bank_mask:0xf
  v_add_f32_dpp v90, v90, v90 row_half_mirror row_mask:0xf bank_mask:0xf
  v_add_f32_dpp v92, v92, v92 row_half_mirror row_mask:0xf bank_mask:0xf
  v_add_f32_dpp v94, v94, v94 row_half_mirror row_mask:0xf bank_mask:0xf
  v_add_f32_dpp v88, v88, v88 row_mirror row_mask:0xf bank_mask:0xf
  v_add_f32_dpp v90, v90, v90 row_mirror row_mask:0xf bank_mask:0xf
  v_add_f32_dpp v92, v92, v92 row_mirror row_mask:0xf bank_mask:0xf
  v_add_f32_dpp v94, v94, v94 row_mirror row_mask:0xf bank_mask:0xf
  v_mov_b32 v84, v88
  v_mov_b32 v85, v90
  v_mov_b32 v86, v92
  v_mov_b32 v87, v94
  v_permlane16_swap_b32 v88, v84
  v_permlane16_swap_b32 v90, v85
  v_permlane16_swap_b32 v92, v86
  v_permlane16_swap_b32 v94, v87
  v_add_f32 v88, v88, v84
  v_add_f32 v90, v90, v85
  v_add_f32 v92, v92, v86
  v_add_f32 v94, v94, v87
  v_mov_b32 v84, v88
  v_mov_b32 v85, v90
  v_mov_b32 v86, v92
  v_mov_b32 v87, v94
  v_permlane32_swap_b32 v88, v84
  v_permlane32_swap_b32 v90, v85
  v_permlane32_swap_b32 v92, v86
  v_permlane32_swap_b32 v94, v87
  v_add_f32 v88, v88, v84
  v_add_f32 v90, v90, v85
  v_add_f32 v92, v92, v86
  v_add_f32 v94, v94, v87
  v_mul_f32 v88, 0x3b124925, v88
  v_mul_f32 v90, 0x3b124925, v90
  v_mul_f32 v92, 0x3b124925, v92
  v_mul_f32 v94, 0x3b124925, v94
  v_pk_add_f32 v[72:73], v[40:41], v[88:89] op_sel:[0,0] op_sel_hi:[1,0] neg_lo:[0,1] neg_hi:[0,1]
  v_pk_add_f32 v[74:75], v[42:43], v[88:89] op_sel:[0,0] op_sel_hi:[1,0] neg_lo:[0,1] neg_hi:[0,1]
  v_pk_add_f32 v[76:77], v[44:45], v[88:89] op_sel:[0,0] op_sel_hi:[1,0] neg_lo:[0,1] neg_hi:[0,1]
  v_pk_add_f32 v[78:79], v[46:47], v[88:89] op_sel:[0,0] op_sel_hi:[1,0] neg_lo:[0,1] neg_hi:[0,1]
  v_pk_mul_f32 v[80:81], v[72:73], v[72:73]
  v_pk_fma_f32 v[80:81], v[74:75], v[74:75], v[80:81]
  v_pk_fma_f32 v[80:81], v[76:77], v[76:77], v[80:81]
  v_pk_fma_f32 v[80:81], v[78:79], v[78:79], v[80:81]
  v_add_f32 v89, v80, v81
  v_and_b32 v89, v89, v21
  v_pk_add_f32 v[72:73], v[48:49], v[90:91] op_sel:[0,0] op_sel_hi:[1,0] neg_lo:[0,1] neg_hi:[0,1]
  v_pk_add_f32 v[74:75], v[50:51], v[90:91] op_sel:[0,0] op_sel_hi:[1,0] neg_lo:[0,1] neg_hi:[0,1]
  v_pk_add_f32 v[76:77], v[52:53], v[90:91] op_sel:[0,0] op_sel_hi:[1,0] neg_lo:[0,1] neg_hi:[0,1]
  v_pk_add_f32 v[78:79], v[54:55], v[90:91] op_sel:[0,0] op_sel_hi:[1,0] neg_lo:[0,1] neg_hi:[0,1]
  v_pk_mul_f32 v[80:81], v[72:73], v[72:73]
  v_pk_fma_f32 v[80:81], v[74:75], v[74:75], v[80:81]
  v_pk_fma_f32 v[80:81], v[76:77], v[76:77], v[80:81]
  v_pk_fma_f32 v[80:81], v[78:79], v[78:79], v[80:81]
  v_add_f32 v91, v80, v81
  v_and_b32 v91, v91, v21
  v_pk_add_f32 v[72:73], v[56:57], v[92:93] op_sel:[0,0] op_sel_hi:[1,0] neg_lo:[0,1] neg_hi:[0,1]
  v_pk_add_f32 v[74:75], v[58:59], v[92:93] op_sel:[0,0] op_sel_hi:[1,0] neg_lo:[0,1] neg_hi:[0,1]
  v_pk_add_f32 v[76:77], v[60:61], v[92:93] op_sel:[0,0] op_sel_hi:[1,0] neg_lo:[0,1] neg_hi:[0,1]
  v_pk_add_f32 v[78:79], v[62:63], v[92:93] op_sel:[0,0] op_sel_hi:[1,0] neg_lo:[0,1] neg_hi:[0,1]
  v_pk_mul_f32 v[80:81], v[72:73], v[72:73]
  v_pk_fma_f32 v[80:81], v[74:75], v[74:75], v[80:81]
  v_pk_fma_f32 v[80:81], v[76:77], v[76:77], v[80:81]
  v_pk_fma_f32 v[80:81], v[78:79], v[78:79], v[80:81]
  v_add_f32 v93, v80, v81
  v_and_b32 v93, v93, v21
  v_pk_add_f32 v[72:73], v[64:65], v[94:95] op_sel:[0,0] op_sel_hi:[1,0] neg_lo:[0,1] neg_hi:[0,1]
  v_pk_add_f32 v[74:75], v[66:67], v[94:95] op_sel:[0,0] op_sel_hi:[1,0] neg_lo:[0,1] neg_hi:[0,1]
  v_pk_add_f32 v[76:77], v[68:69], v[94:95] op_sel:[0,0] op_sel_hi:[1,0] neg_lo:[0,1] neg_hi:[0,1]
  v_pk_add_f32 v[78:79], v[70:71], v[94:95] op_sel:[0,0] op_sel_hi:[1,0] neg_lo:[0,1] neg_hi:[0,1]
  v_pk_mul_f32 v[80:81], v[72:73], v[72:73]
  v_pk_fma_f32 v[80:81], v[74:75], v[74:75], v[80:81]
  v_pk_fma_f32 v[80:81], v[76:77], v[76:77], v[80:81]
  v_pk_fma_f32 v[80:81], v[78:79], v[78:79], v[80:81]
  v_add_f32 v95, v80, v81
  v_and_b32 v95, v95, v21
  v_add_f32_dpp v89, v89, v89 quad_perm:[1,0,3,2] row_mask:0xf bank_mask:0xf
  v_add_f32_dpp v91, v91, v91 quad_perm:[1,0,3,2] row_mask:0xf bank_mask:0xf
  v_add_f32_dpp v93, v93, v93 quad_perm:[1,0,3,2] row_mask:0xf bank_mask:0xf
  v_add_f32_dpp v95, v95, v95 quad_perm:[1,0,3,2] row_mask:0xf bank_mask:0xf
  v_add_f32_dpp v89, v89, v89 quad_perm:[2,3,0,1] row_mask:0xf bank_mask:0xf
  v_add_f32_dpp v91, v91, v91 quad_perm:[2,3,0,1] row_mask:0xf bank_mask:0xf
  v_add_f32_dpp v93, v93, v93 quad_perm:[2,3,0,1] row_mask:0xf bank_mask:0xf
  v_add_f32_dpp v95, v95, v95 quad_perm:[2,3,0,1] row_mask:0xf bank_mask:0xf
  v_add_f32_dpp v89, v89, v89 row_half_mirror row_mask:0xf bank_mask:0xf
  v_add_f32_dpp v91, v91, v91 row_half_mirror row_mask:0xf bank_mask:0xf
  v_add_f32_dpp v93, v93, v93 row_half_mirror row_mask:0xf bank_mask:0xf
  v_add_f32_dpp v95, v95, v95 row_half_mirror row_mask:0xf bank_mask:0xf
  v_add_f32_dpp v89, v89, v89 row_mirror row_mask:0xf bank_mask:0xf
  v_add_f32_dpp v91, v91, v91 row_mirror row_mask:0xf bank_mask:0xf
  v_add_f32_dpp v93, v93, v93 row_mirror row_mask:0xf bank_mask:0xf
  v_add_f32_dpp v95, v95, v95 row_mirror row_mask:0xf bank_mask:0xf
  v_mov_b32 v84, v89
  v_mov_b32 v85, v91
  v_mov_b32 v86, v93
  v_mov_b32 v87, v95
  v_permlane16_swap_b32 v89, v84
  v_permlane16_swap_b32 v91, v85
  v_permlane16_swap_b32 v93, v86
  v_permlane16_swap_b32 v95, v87
  v_add_f32 v89, v89, v84
  v_add_f32 v91, v91, v85
  v_add_f32 v93, v93, v86
  v_add_f32 v95, v95, v87
  v_mov_b32 v84, v89
  v_mov_b32 v85, v91
  v_mov_b32 v86, v93
  v_mov_b32 v87, v95
  v_permlane32_swap_b32 v89, v84
  v_permlane32_swap_b32 v91, v85
  v_permlane32_swap_b32 v93, v86
  v_permlane32_swap_b32 v95, v87
  v_add_f32 v89, v89, v84
  v_add_f32 v91, v91, v85
  v_add_f32 v93, v93, v86
  v_add_f32 v95, v95, v87
  v_mul_f32 v89, 0x3b124925, v89
  v_mul_f32 v91, 0x3b124925, v91
  v_mul_f32 v93, 0x3b124925, v93
  v_mul_f32 v95, 0x3b124925, v95
  v_cvt_pk_bf16_f32 v96, v88, v89
  v_lshlrev_b32 v88, 16, v96
  v_and_b32 v89, 0xffff0000, v96
  v_cvt_pk_bf16_f32 v98, v90, v91
  v_lshlrev_b32 v90, 16, v98
  v_and_b32 v91, 0xffff0000, v98
  v_cvt_pk_bf16_f32 v100, v92, v93
  v_lshlrev_b32 v92, 16, v100
  v_and_b32 v93, 0xffff0000, v100
  v_cvt_pk_bf16_f32 v102, v94, v95
  v_lshlrev_b32 v94, 16, v102
  v_and_b32 v95, 0xffff0000, v102
  v_add_f32 v89, 0x3727c5ac, v89
  v_add_f32 v91, 0x3727c5ac, v91
  v_add_f32 v93, 0x3727c5ac, v93
  v_add_f32 v95, 0x3727c5ac, v95
  v_cvt_pk_bf16_f32 v89, v89, v89
  v_and_b32 v89, 0xffff0000, v89
  v_cvt_pk_bf16_f32 v91, v91, v91
  v_and_b32 v91, 0xffff0000, v91
  v_cvt_pk_bf16_f32 v93, v93, v93
  v_and_b32 v93, 0xffff0000, v93
  v_cvt_pk_bf16_f32 v95, v95, v95
  v_and_b32 v95, 0xffff0000, v95
  v_sqrt_f32 v89, v89
  v_sqrt_f32 v91, v91
  v_sqrt_f32 v93, v93
  v_sqrt_f32 v95, v95
  v_cvt_pk_bf16_f32 v89, v89, v89
  v_and_b32 v89, 0xffff0000, v89
  v_cvt_pk_bf16_f32 v91, v91, v91
  v_and_b32 v91, 0xffff0000, v91
  v_cvt_pk_bf16_f32 v93, v93, v93
  v_and_b32 v93, 0xffff0000, v93
  v_cvt_pk_bf16_f32 v95, v95, v95
  v_and_b32 v95, 0xffff0000, v95
  v_rcp_f32 v96, v89
  v_rcp_f32 v98, v91
  v_rcp_f32 v100, v93
  v_rcp_f32 v102, v95
  v_pk_add_f32 v[40:41], v[40:41], v[88:89] op_sel:[0,0] op_sel_hi:[1,0] neg_lo:[0,1] neg_hi:[0,1]
  v_cvt_pk_bf16_f32 v84, v40, v41
  v_lshlrev_b32 v40, 16, v84
  v_and_b32 v41, 0xffff0000, v84
  v_pk_mul_f32 v[40:41], v[40:41], v[96:97] op_sel:[0,0] op_sel_hi:[1,0]
  v_cvt_pk_bf16_f32 v84, v40, v41
  v_lshlrev_b32 v40, 16, v84
  v_and_b32 v41, 0xffff0000, v84
  v_pk_add_f32 v[42:43], v[42:43], v[88:89] op_sel:[0,0] op_sel_hi:[1,0] neg_lo:[0,1] neg_hi:[0,1]
  v_cvt_pk_bf16_f32 v84, v42, v43
  v_lshlrev_b32 v42, 16, v84
  v_and_b32 v43, 0xffff0000, v84
  v_pk_mul_f32 v[42:43], v[42:43], v[96:97] op_sel:[0,0] op_sel_hi:[1,0]
  v_cvt_pk_bf16_f32 v84, v42, v43
  v_lshlrev_b32 v42, 16, v84
  v_and_b32 v43, 0xffff0000, v84
  v_pk_add_f32 v[44:45], v[44:45], v[88:89] op_sel:[0,0] op_sel_hi:[1,0] neg_lo:[0,1] neg_hi:[0,1]
  v_cvt_pk_bf16_f32 v84, v44, v45
  v_lshlrev_b32 v44, 16, v84
  v_and_b32 v45, 0xffff0000, v84
  v_pk_mul_f32 v[44:45], v[44:45], v[96:97] op_sel:[0,0] op_sel_hi:[1,0]
  v_cvt_pk_bf16_f32 v84, v44, v45
  v_lshlrev_b32 v44, 16, v84
  v_and_b32 v45, 0xffff0000, v84
  v_pk_add_f32 v[46:47], v[46:47], v[88:89] op_sel:[0,0] op_sel_hi:[1,0] neg_lo:[0,1] neg_hi:[0,1]
  v_cvt_pk_bf16_f32 v84, v46, v47
  v_lshlrev_b32 v46, 16, v84
  v_and_b32 v47, 0xffff0000, v84
  v_pk_mul_f32 v[46:47], v[46:47], v[96:97] op_sel:[0,0] op_sel_hi:[1,0]
  v_cvt_pk_bf16_f32 v84, v46, v47
  v_lshlrev_b32 v46, 16, v84
  v_and_b32 v47, 0xffff0000, v84
  v_pk_add_f32 v[48:49], v[48:49], v[90:91] op_sel:[0,0] op_sel_hi:[1,0] neg_lo:[0,1] neg_hi:[0,1]
  v_cvt_pk_bf16_f32 v84, v48, v49
  v_lshlrev_b32 v48, 16, v84
  v_and_b32 v49, 0xffff0000, v84
  v_pk_mul_f32 v[48:49], v[48:49], v[98:99] op_sel:[0,0] op_sel_hi:[1,0]
  v_cvt_pk_bf16_f32 v84, v48, v49
  v_lshlrev_b32 v48, 16, v84
  v_and_b32 v49, 0xffff0000, v84
  v_pk_add_f32 v[50:51], v[50:51], v[90:91] op_sel:[0,0] op_sel_hi:[1,0] neg_lo:[0,1] neg_hi:[0,1]
  v_cvt_pk_bf16_f32 v84, v50, v51
  v_lshlrev_b32 v50, 16, v84
  v_and_b32 v51, 0xffff0000, v84
  v_pk_mul_f32 v[50:51], v[50:51], v[98:99] op_sel:[0,0] op_sel_hi:[1,0]
  v_cvt_pk_bf16_f32 v84, v50, v51
  v_lshlrev_b32 v50, 16, v84
  v_and_b32 v51, 0xffff0000, v84
  v_pk_add_f32 v[52:53], v[52:53], v[90:91] op_sel:[0,0] op_sel_hi:[1,0] neg_lo:[0,1] neg_hi:[0,1]
  v_cvt_pk_bf16_f32 v84, v52, v53
  v_lshlrev_b32 v52, 16, v84
  v_and_b32 v53, 0xffff0000, v84
  v_pk_mul_f32 v[52:53], v[52:53], v[98:99] op_sel:[0,0] op_sel_hi:[1,0]
  v_cvt_pk_bf16_f32 v84, v52, v53
  v_lshlrev_b32 v52, 16, v84
  v_and_b32 v53, 0xffff0000, v84
  v_pk_add_f32 v[54:55], v[54:55], v[90:91] op_sel:[0,0] op_sel_hi:[1,0] neg_lo:[0,1] neg_hi:[0,1]
  v_cvt_pk_bf16_f32 v84, v54, v55
  v_lshlrev_b32 v54, 16, v84
  v_and_b32 v55, 0xffff0000, v84
  v_pk_mul_f32 v[54:55], v[54:55], v[98:99] op_sel:[0,0] op_sel_hi:[1,0]
  v_cvt_pk_bf16_f32 v84, v54, v55
  v_lshlrev_b32 v54, 16, v84
  v_and_b32 v55, 0xffff0000, v84
  v_pk_add_f32 v[56:57], v[56:57], v[92:93] op_sel:[0,0] op_sel_hi:[1,0] neg_lo:[0,1] neg_hi:[0,1]
  v_cvt_pk_bf16_f32 v84, v56, v57
  v_lshlrev_b32 v56, 16, v84
  v_and_b32 v57, 0xffff0000, v84
  v_pk_mul_f32 v[56:57], v[56:57], v[100:101] op_sel:[0,0] op_sel_hi:[1,0]
  v_cvt_pk_bf16_f32 v84, v56, v57
  v_lshlrev_b32 v56, 16, v84
  v_and_b32 v57, 0xffff0000, v84
  v_pk_add_f32 v[58:59], v[58:59], v[92:93] op_sel:[0,0] op_sel_hi:[1,0] neg_lo:[0,1] neg_hi:[0,1]
  v_cvt_pk_bf16_f32 v84, v58, v59
  v_lshlrev_b32 v58, 16, v84
  v_and_b32 v59, 0xffff0000, v84
  v_pk_mul_f32 v[58:59], v[58:59], v[100:101] op_sel:[0,0] op_sel_hi:[1,0]
  v_cvt_pk_bf16_f32 v84, v58, v59
  v_lshlrev_b32 v58, 16, v84
  v_and_b32 v59, 0xffff0000, v84
  v_pk_add_f32 v[60:61], v[60:61], v[92:93] op_sel:[0,0] op_sel_hi:[1,0] neg_lo:[0,1] neg_hi:[0,1]
  v_cvt_pk_bf16_f32 v84, v60, v61
  v_lshlrev_b32 v60, 16, v84
  v_and_b32 v61, 0xffff0000, v84
  v_pk_mul_f32 v[60:61], v[60:61], v[100:101] op_sel:[0,0] op_sel_hi:[1,0]
  v_cvt_pk_bf16_f32 v84, v60, v61
  v_lshlrev_b32 v60, 16, v84
  v_and_b32 v61, 0xffff0000, v84
  v_pk_add_f32 v[62:63], v[62:63], v[92:93] op_sel:[0,0] op_sel_hi:[1,0] neg_lo:[0,1] neg_hi:[0,1]
  v_cvt_pk_bf16_f32 v84, v62, v63
  v_lshlrev_b32 v62, 16, v84
  v_and_b32 v63, 0xffff0000, v84
  v_pk_mul_f32 v[62:63], v[62:63], v[100:101] op_sel:[0,0] op_sel_hi:[1,0]
  v_cvt_pk_bf16_f32 v84, v62, v63
  v_lshlrev_b32 v62, 16, v84
  v_and_b32 v63, 0xffff0000, v84
  v_pk_add_f32 v[64:65], v[64:65], v[94:95] op_sel:[0,0] op_sel_hi:[1,0] neg_lo:[0,1] neg_hi:[0,1]
  v_cvt_pk_bf16_f32 v84, v64, v65
  v_lshlrev_b32 v64, 16, v84
  v_and_b32 v65, 0xffff0000, v84
  v_pk_mul_f32 v[64:65], v[64:65], v[102:103] op_sel:[0,0] op_sel_hi:[1,0]
  v_cvt_pk_bf16_f32 v84, v64, v65
  v_lshlrev_b32 v64, 16, v84
  v_and_b32 v65, 0xffff0000, v84
  v_pk_add_f32 v[66:67], v[66:67], v[94:95] op_sel:[0,0] op_sel_hi:[1,0] neg_lo:[0,1] neg_hi:[0,1]
  v_cvt_pk_bf16_f32 v84, v66, v67
  v_lshlrev_b32 v66, 16, v84
  v_and_b32 v67, 0xffff0000, v84
  v_pk_mul_f32 v[66:67], v[66:67], v[102:103] op_sel:[0,0] op_sel_hi:[1,0]
  v_cvt_pk_bf16_f32 v84, v66, v67
  v_lshlrev_b32 v66, 16, v84
  v_and_b32 v67, 0xffff0000, v84
  v_pk_add_f32 v[68:69], v[68:69], v[94:95] op_sel:[0,0] op_sel_hi:[1,0] neg_lo:[0,1] neg_hi:[0,1]
  v_cvt_pk_bf16_f32 v84, v68, v69
  v_lshlrev_b32 v68, 16, v84
  v_and_b32 v69, 0xffff0000, v84
  v_pk_mul_f32 v[68:69], v[68:69], v[102:103] op_sel:[0,0] op_sel_hi:[1,0]
  v_cvt_pk_bf16_f32 v84, v68, v69
  v_lshlrev_b32 v68, 16, v84
  v_and_b32 v69, 0xffff0000, v84
  v_pk_add_f32 v[70:71], v[70:71], v[94:95] op_sel:[0,0] op_sel_hi:[1,0] neg_lo:[0,1] neg_hi:[0,1]
  v_cvt_pk_bf16_f32 v84, v70, v71
  v_lshlrev_b32 v70, 16, v84
  v_and_b32 v71, 0xffff0000, v84
  v_pk_mul_f32 v[70:71], v[70:71], v[102:103] op_sel:[0,0] op_sel_hi:[1,0]
  v_cvt_pk_bf16_f32 v84, v70, v71
  v_lshlrev_b32 v70, 16, v84
  v_and_b32 v71, 0xffff0000, v84
  s_waitcnt lgkmcnt(0)
  s_mul_i32 s81, s81, 0x9E3779B1
  s_add_u32 s81, s81, 0x7F4A7C15
  s_and_b32 s2, s81, 0xffff
  s_mov_b32 s14, 401408
  s_mov_b32 s15, 0x20000
  s_mov_b32 s18, 1605632
  s_mov_b32 s19, 0x20000
  s_mov_b32 s22, 1605632
  s_mov_b32 s23, 0x20000
  s_mov_b32 s26, 1605632
  s_mov_b32 s27, 0x20000
  s_mov_b32 s38, 1835008
  s_mov_b32 s39, 0x20000
  s_sub_u32 s50, 31, s54
  s_mul_i32 s98, s53, 7
  s_lshr_b32 s98, s98, 1
  s_add_u32 s51, s50, s98
  s_sub_u32 s98, s51, 28
  s_cmp_ge_u32 s51, 28
  s_cselect_b32 s51, s98, s51
  s_lshr_b32 s58, s54, 4
  s_lshl_b32 s58, s58, 2
  s_add_u32 s58, s58, 1
  s_mul_i32 s59, s50, 37
  s_lshr_b32 s59, s59, 8
  s_mul_i32 s60, s59, 7
  s_sub_u32 s60, s50, s60
  s_mul_i32 s61, s53, 258048
  s_add_u32 s61, s61, 393216
  s_and_b32 s98, s52, 1
  s_lshl_b32 s99, s59, 1
  s_add_u32 s62, s98, s99
  s_lshr_b32 s63, s52, 1
  s_sub_u32 s82, s50, 16
  s_cmp_ge_i32 s82, 7
  s_cselect_b32 s98, 7, 0
  s_cselect_b32 s83, 4, 0
  s_sub_u32 s82, s82, s98
  s_max_i32 s82, s82, 0
  s_min_i32 s82, s82, 6
  s_and_b32 s98, s52, 3
  s_add_u32 s83, s83, s98
  s_and_b32 s93, s57, 1
  s_lshl_b32 s93, s93, 3
  s_add_u32 s93, s93, 77824
  v_lshl_add_u32 v13, v9, 3, v10
  v_mul_u32_u24 v104, 192, v13
  v_lshl_add_u32 v104, v16, 5, v104
  v_lshl_add_u32 v104, v11, 3, v104
  v_add_u32 v104, s93, v104
  v_add_u32 v105, 43008, v104
  v_lshrrev_b32 v12, 4, v1
  v_lshlrev_b32 v12, 2, v12
  v_and_b32 v13, 15, v1
  v_sub_u32 v12, v13, v12
  v_mov_b32 v14, 0xf149f2ca
  v_add_u32 v13, 16, v12
  v_and_b32 v13, 0xfffffff1, v13
  v_cmp_eq_u32 vcc, 0, v13
  s_nop 1
  v_cndmask_b32_e64 v108, v14, 0, vcc
  v_add_u32 v13, 15, v12
  v_and_b32 v13, 0xfffffff1, v13
  v_cmp_eq_u32 vcc, 0, v13
  s_nop 1
  v_cndmask_b32_e64 v109, v14, 0, vcc
  v_add_u32 v13, 14, v12
  v_and_b32 v13, 0xfffffff1, v13
  v_cmp_eq_u32 vcc, 0, v13
  s_nop 1
  v_cndmask_b32_e64 v110, v14, 0, vcc
  v_add_u32 v13, 13, v12
  v_and_b32 v13, 0xfffffff1, v13
  v_cmp_eq_u32 vcc, 0, v13
  s_nop 1
  v_cndmask_b32_e64 v111, v14, 0, vcc
  v_add_u32 v13, 0, v12
  v_and_b32 v13, 0xfffffff1, v13
  v_cmp_eq_u32 vcc, 0, v13
  s_nop 1
  v_cndmask_b32_e64 v112, v14, 0, vcc
  v_add_u32 v13, -1, v12
  v_and_b32 v13, 0xfffffff1, v13
  v_cmp_eq_u32 vcc, 0, v13
  s_nop 1
  v_cndmask_b32_e64 v113, v14, 0, vcc
  v_add_u32 v13, -2, v12
  v_and_b32 v13, 0xfffffff1, v13
  v_cmp_eq_u32 vcc, 0, v13
  s_nop 1
  v_cndmask_b32_e64 v114, v14, 0, vcc
  v_add_u32 v13, -3, v12
  v_and_b32 v13, 0xfffffff1, v13
  v_cmp_eq_u32 vcc, 0, v13
  s_nop 1
  v_cndmask_b32_e64 v115, v14, 0, vcc
  s_add_u32 s88, s58, s52
  s_lshl_b32 s89, s53, 4
  s_add_u32 s89, s89, s88
  s_cmp_eq_u32 s89, 1
  s_cselect_b64 vcc, -1, 0
  v_cndmask_b32 v116, v108, v14, vcc
  v_cndmask_b32 v117, v109, v14, vcc
  v_cndmask_b32 v118, v110, v14, vcc
  v_cndmask_b32 v119, v111, v14, vcc
  v_mov_b32 v5, 1
  v_mov_b32 v6, 1
  v_mov_b32 v7, 1
  s_mov_b32 s99, 1048576
adaLN_cond__sliding_local_dilated__glu_gated_geglu__prompt_kernel_p23:
  ds_read_b32 v8, v18 offset:0
  s_waitcnt lgkmcnt(0)
  v_cmp_gt_u32 vcc, 1, v8
  s_sub_u32 s99, s99, 1
  s_cbranch_scc1 adaLN_cond__sliding_local_dilated__glu_gated_geglu__prompt_kernel_d24
  s_cbranch_vccnz adaLN_cond__sliding_local_dilated__glu_gated_geglu__prompt_kernel_p23
adaLN_cond__sliding_local_dilated__glu_gated_geglu__prompt_kernel_d24:
  v_readfirstlane_b32 s55, v8
  s_nop 0
  s_sub_u32 s55, s55, 1
  s_lshr_b32 s89, s91, 5
  s_mul_i32 s89, s89, 28672
  s_and_b32 s88, s91, 31
  s_lshl_b32 s88, s88, 4
  s_add_u32 s89, s89, s88
  s_add_u32 s94, s89, s61
  s_add_u32 s95, s94, 8192
  s_add_u32 s96, s94, 16384
  s_add_u32 s97, s94, 24576
  s_lshl_b32 s90, s91, 2
  s_add_u32 s90, s90, s56
  s_mov_b32 s88, 327680
  s_lshl_b32 s89, s52, 12
  s_add_u32 s89, s89, 131072
  v_lshl_add_u32 v88, v1, 6, s89
  v_add_u32 v89, s89, v2
  v_lshrrev_b32 v90, 2, v1
  v_lshlrev_b32 v90, 9, v90
  v_lshl_add_u32 v90, v11, 4, v90
  s_add_u32 s89, s56, 1280
  v_min_u32 v3, 0, v1
  v_lshlrev_b32 v3, 2, v3
  s_mov_b32 s99, 262144
adaLN_cond__sliding_local_dilated__glu_gated_geglu__prompt_kernel_p25:
  buffer_load_dword v8, v3, s[44:47], s89 offen sc1
  s_waitcnt vmcnt(0)
  v_cmp_ne_u32 vcc, 1, v8
  s_sub_u32 s99, s99, 1
  s_cbranch_scc1 adaLN_cond__sliding_local_dilated__glu_gated_geglu__prompt_kernel_d26
  s_cbranch_vccnz adaLN_cond__sliding_local_dilated__glu_gated_geglu__prompt_kernel_p25
adaLN_cond__sliding_local_dilated__glu_gated_geglu__prompt_kernel_d26:
  s_mov_b32 s99, 262144
  s_mov_b32 exec_hi, 0x00ffffff
adaLN_cond__sliding_local_dilated__glu_gated_geglu__prompt_kernel_p27:
  buffer_load_dwordx4 v[80:83], v2, s[44:47], s88 offen offset:1792 sc1
  buffer_load_dwordx4 v[84:87], v2, s[44:47], s88 offen offset:2688 sc1
  buffer_load_dwordx4 v[72:75], v2, s[44:47], s88 offen offset:0 sc1
  buffer_load_dwordx4 v[76:79], v2, s[44:47], s88 offen offset:896 sc1
  s_waitcnt vmcnt(0)
  v_xor_b32 v8, s2, v72
  v_xor_b32 v3, s2, v73
  v_bitop3_b32 v8, v8, v74, s2 bitop3:0xf6
  v_bitop3_b32 v3, v3, v75, s2 bitop3:0xf6
  v_bitop3_b32 v8, v8, v76, s2 bitop3:0xf6
  v_bitop3_b32 v3, v3, v77, s2 bitop3:0xf6
  v_bitop3_b32 v8, v8, v78, s2 bitop3:0xf6
  v_bitop3_b32 v3, v3, v79, s2 bitop3:0xf6
  v_bitop3_b32 v8, v8, v80, s2 bitop3:0xf6
  v_bitop3_b32 v3, v3, v81, s2 bitop3:0xf6
  v_bitop3_b32 v8, v8, v82, s2 bitop3:0xf6
  v_bitop3_b32 v3, v3, v83, s2 bitop3:0xf6
  v_bitop3_b32 v8, v8, v84, s2 bitop3:0xf6
  v_bitop3_b32 v3, v3, v85, s2 bitop3:0xf6
  v_bitop3_b32 v8, v8, v86, s2 bitop3:0xf6
  v_bitop3_b32 v3, v3, v87, s2 bitop3:0xf6
  v_or_b32 v8, v8, v3
  v_and_b32 v8, 0xffff, v8
  v_cmp_ne_u32 vcc, 0, v8
  s_sub_u32 s99, s99, 1
  s_cbranch_scc1 adaLN_cond__sliding_local_dilated__glu_gated_geglu__prompt_kernel_d28
  s_cbranch_vccnz adaLN_cond__sliding_local_dilated__glu_gated_geglu__prompt_kernel_p27
adaLN_cond__sliding_local_dilated__glu_gated_geglu__prompt_kernel_d28:
  v_and_b32 v72, 0xffff0000, v72
  v_and_b32 v73, 0xffff0000, v73
  v_and_b32 v74, 0xffff0000, v74
  v_and_b32 v75, 0xffff0000, v75
  v_and_b32 v76, 0xffff0000, v76
  v_and_b32 v77, 0xffff0000, v77
  v_and_b32 v78, 0xffff0000, v78
  v_and_b32 v79, 0xffff0000, v79
  v_and_b32 v80, 0xffff0000, v80
  v_and_b32 v81, 0xffff0000, v81
  v_and_b32 v82, 0xffff0000, v82
  v_and_b32 v83, 0xffff0000, v83
  v_and_b32 v84, 0xffff0000, v84
  v_and_b32 v85, 0xffff0000, v85
  v_and_b32 v86, 0xffff0000, v86
  v_and_b32 v87, 0xffff0000, v87
  v_pk_fma_f32 v[40:41], v[40:41], v[80:81], v[72:73]
  v_pk_fma_f32 v[42:43], v[42:43], v[82:83], v[74:75]
  v_pk_fma_f32 v[44:45], v[44:45], v[84:85], v[76:77]
  v_pk_fma_f32 v[46:47], v[46:47], v[86:87], v[78:79]
  v_cvt_pk_bf16_f32 v24, v40, v41
  v_cvt_pk_bf16_f32 v25, v42, v43
  v_cvt_pk_bf16_f32 v26, v44, v45
  v_cvt_pk_bf16_f32 v27, v46, v47
  ds_write_b128 v88, v[24:27] offset:0
  v_pk_fma_f32 v[48:49], v[48:49], v[80:81], v[72:73]
  v_pk_fma_f32 v[50:51], v[50:51], v[82:83], v[74:75]
  v_pk_fma_f32 v[52:53], v[52:53], v[84:85], v[76:77]
  v_pk_fma_f32 v[54:55], v[54:55], v[86:87], v[78:79]
  v_cvt_pk_bf16_f32 v28, v48, v49
  v_cvt_pk_bf16_f32 v29, v50, v51
  v_cvt_pk_bf16_f32 v30, v52, v53
  v_cvt_pk_bf16_f32 v31, v54, v55
  ds_write_b128 v88, v[28:31] offset:16
  v_pk_fma_f32 v[56:57], v[56:57], v[80:81], v[72:73]
  v_pk_fma_f32 v[58:59], v[58:59], v[82:83], v[74:75]
  v_pk_fma_f32 v[60:61], v[60:61], v[84:85], v[76:77]
  v_pk_fma_f32 v[62:63], v[62:63], v[86:87], v[78:79]
  v_cvt_pk_bf16_f32 v32, v56, v57
  v_cvt_pk_bf16_f32 v33, v58, v59
  v_cvt_pk_bf16_f32 v34, v60, v61
  v_cvt_pk_bf16_f32 v35, v62, v63
  ds_write_b128 v88, v[32:35] offset:32
  v_pk_fma_f32 v[64:65], v[64:65], v[80:81], v[72:73]
  v_pk_fma_f32 v[66:67], v[66:67], v[82:83], v[74:75]
  v_pk_fma_f32 v[68:69], v[68:69], v[84:85], v[76:77]
  v_pk_fma_f32 v[70:71], v[70:71], v[86:87], v[78:79]
  v_cvt_pk_bf16_f32 v36, v64, v65
  v_cvt_pk_bf16_f32 v37, v66, v67
  v_cvt_pk_bf16_f32 v38, v68, v69
  v_cvt_pk_bf16_f32 v39, v70, v71
  ds_write_b128 v88, v[36:39] offset:48
  s_mov_b32 exec_hi, -1
  s_waitcnt lgkmcnt(0)
  ds_read_b128 v[40:43], v89 offset:0
  ds_read_b128 v[44:47], v89 offset:1024
  ds_read_b128 v[48:51], v89 offset:2048
  ds_read_b128 v[52:55], v89 offset:3072
  s_waitcnt lgkmcnt(3)
  s_waitcnt lgkmcnt(2)
  s_waitcnt lgkmcnt(1)
  s_waitcnt lgkmcnt(0)
  s_cmp_lg_u32 s55, 0
  s_cbranch_scc1 adaLN_cond__sliding_local_dilated__glu_gated_geglu__prompt_kernel_m29
  buffer_store_dwordx4 v[40:43], v90, s[44:47], s94 offen
  buffer_store_dwordx4 v[44:47], v90, s[44:47], s95 offen
  buffer_store_dwordx4 v[48:51], v90, s[44:47], s96 offen
  s_mov_b32 exec_hi, 0
  buffer_store_dwordx4 v[52:55], v90, s[44:47], s97 offen
  s_waitcnt vmcnt(0)
  s_mov_b64 exec, 1
  buffer_store_dwordx4 v[4:7], off, s[44:47], s90
  s_mov_b64 exec, -1
adaLN_cond__sliding_local_dilated__glu_gated_geglu__prompt_kernel_e30:
  s_cmp_ge_u32 s52, 4
  s_cbranch_scc1 L_h67j
L_p1:
  s_add_u32 s88, s58, s52
  s_lshl_b32 s89, s88, 7
  s_add_u32 s89, s89, s56
  s_mul_i32 s93, s88, 28672
  s_add_u32 s93, s93, s61
  v_min_u32 v3, 31, v1
  v_lshlrev_b32 v3, 2, v3
  s_mov_b32 s99, 262144
adaLN_cond__sliding_local_dilated__glu_gated_geglu__prompt_kernel_p31:
  buffer_load_dword v8, v3, s[44:47], s89 offen sc1
  s_waitcnt vmcnt(0)
  v_cmp_ne_u32 vcc, 1, v8
  s_sub_u32 s99, s99, 1
  s_cbranch_scc1 adaLN_cond__sliding_local_dilated__glu_gated_geglu__prompt_kernel_d32
  s_cbranch_vccnz adaLN_cond__sliding_local_dilated__glu_gated_geglu__prompt_kernel_p31
adaLN_cond__sliding_local_dilated__glu_gated_geglu__prompt_kernel_d32:
  buffer_load_dwordx4 v[120:123], v2, s[44:47], s93 offen offset:0 sc1
  buffer_load_dwordx4 v[124:127], v2, s[44:47], s93 offen offset:1024 sc1
  buffer_load_dwordx4 v[128:131], v2, s[44:47], s93 offen offset:2048 sc1
  buffer_load_dwordx4 v[132:135], v2, s[44:47], s93 offen offset:3072 sc1
  s_add_u32 s93, s93, 4096
  buffer_load_dwordx4 v[136:139], v2, s[44:47], s93 offen offset:0 sc1
  buffer_load_dwordx4 v[140:143], v2, s[44:47], s93 offen offset:1024 sc1
  buffer_load_dwordx4 v[144:147], v2, s[44:47], s93 offen offset:2048 sc1
  buffer_load_dwordx4 v[148:151], v2, s[44:47], s93 offen offset:3072 sc1
  ds_read_b64 v[20:21], v18 offset:8
  s_waitcnt lgkmcnt(0)
  v_min_u32 v20, v20, v21
  v_cmp_gt_u32 vcc, 2, v20
  s_nop 0
  s_cbranch_vccnz adaLN_cond__sliding_local_dilated__glu_gated_geglu__prompt_kernel_g33
adaLN_cond__sliding_local_dilated__glu_gated_geglu__prompt_kernel_h34:
  ds_read_b64_tr_b16 v[72:73], v104 offset:0
  ds_read_b64_tr_b16 v[74:75], v104 offset:768
  ds_read_b64_tr_b16 v[76:77], v104 offset:64
  ds_read_b64_tr_b16 v[78:79], v104 offset:832
  ds_read_b64_tr_b16 v[80:81], v104 offset:128
  ds_read_b64_tr_b16 v[82:83], v104 offset:896
  s_waitcnt vmcnt(7)
  s_waitcnt lgkmcnt(4)
  v_mfma_f32_32x32x16_bf16 v[24:39], v[72:75], v[120:123], 0
  ds_read_b64_tr_b16 v[84:85], v104 offset:3072
  ds_read_b64_tr_b16 v[86:87], v104 offset:3840
  s_add_u32 s93, s93, 4096
  buffer_load_dwordx4 v[152:155], v2, s[44:47], s93 offen offset:0 sc1
  s_waitcnt lgkmcnt(4)
  v_mfma_f32_32x32x16_bf16 v[40:55], v[76:79], v[120:123], 0
  ds_read_b64_tr_b16 v[88:89], v104 offset:3136
  ds_read_b64_tr_b16 v[90:91], v104 offset:3904
  s_waitcnt lgkmcnt(4)
  v_mfma_f32_32x32x16_bf16 v[56:71], v[120:123], v[80:83], 0
  ds_read_b64_tr_b16 v[92:93], v104 offset:3200
  ds_read_b64_tr_b16 v[94:95], v104 offset:3968
  buffer_load_dwordx4 v[156:159], v2, s[44:47], s93 offen offset:1024 sc1
  s_waitcnt vmcnt(8)
  s_waitcnt lgkmcnt(4)
  v_mfma_f32_32x32x16_bf16 v[24:39], v[84:87], v[124:127], v[24:39]
  ds_read_b64_tr_b16 v[72:73], v104 offset:6144
  ds_read_b64_tr_b16 v[74:75], v104 offset:6912
  buffer_load_dwordx4 v[160:163], v2, s[44:47], s93 offen offset:2048 sc1
  s_waitcnt lgkmcnt(4)
  v_mfma_f32_32x32x16_bf16 v[40:55], v[88:91], v[124:127], v[40:55]
  ds_read_b64_tr_b16 v[76:77], v104 offset:6208
  ds_read_b64_tr_b16 v[78:79], v104 offset:6976
  s_waitcnt lgkmcnt(4)
  v_mfma_f32_32x32x16_bf16 v[56:71], v[124:127], v[92:95], v[56:71]
  ds_read_b64_tr_b16 v[80:81], v104 offset:6272
  ds_read_b64_tr_b16 v[82:83], v104 offset:7040
  buffer_load_dwordx4 v[164:167], v2, s[44:47], s93 offen offset:3072 sc1
  ds_read_b64 v[20:21], v18 offset:8
  s_waitcnt vmcnt(9)
  s_waitcnt lgkmcnt(5)
  v_mfma_f32_32x32x16_bf16 v[24:39], v[72:75], v[128:131], v[24:39]
  ds_read_b64_tr_b16 v[84:85], v104 offset:9216
  ds_read_b64_tr_b16 v[86:87], v104 offset:9984
  s_add_u32 s93, s93, 4096
  buffer_load_dwordx4 v[168:171], v2, s[44:47], s93 offen offset:0 sc1
  s_waitcnt lgkmcnt(5)
  v_mfma_f32_32x32x16_bf16 v[40:55], v[76:79], v[128:131], v[40:55]
  ds_read_b64_tr_b16 v[88:89], v104 offset:9280
  ds_read_b64_tr_b16 v[90:91], v104 offset:10048
  s_waitcnt lgkmcnt(5)
  v_mfma_f32_32x32x16_bf16 v[56:71], v[128:131], v[80:83], v[56:71]
  ds_read_b64_tr_b16 v[92:93], v104 offset:9344
  ds_read_b64_tr_b16 v[94:95], v104 offset:10112
  buffer_load_dwordx4 v[172:175], v2, s[44:47], s93 offen offset:1024 sc1
  s_waitcnt lgkmcnt(6)
  v_min_u32 v20, v20, v21
  v_cmp_gt_u32 vcc, 4, v20
  s_nop 0
  s_cbranch_vccnz adaLN_cond__sliding_local_dilated__glu_gated_geglu__prompt_kernel_g35
adaLN_cond__sliding_local_dilated__glu_gated_geglu__prompt_kernel_h36:
  s_waitcnt vmcnt(10)
  s_waitcnt lgkmcnt(4)
  v_mfma_f32_32x32x16_bf16 v[24:39], v[84:87], v[132:135], v[24:39]
  ds_read_b64_tr_b16 v[72:73], v104 offset:12288
  ds_read_b64_tr_b16 v[74:75], v104 offset:13056
  buffer_load_dwordx4 v[176:179], v2, s[44:47], s93 offen offset:2048 sc1
  s_waitcnt lgkmcnt(4)
  v_mfma_f32_32x32x16_bf16 v[40:55], v[88:91], v[132:135], v[40:55]
  ds_read_b64_tr_b16 v[76:77], v104 offset:12352
  ds_read_b64_tr_b16 v[78:79], v104 offset:13120
  s_waitcnt lgkmcnt(4)
  v_mfma_f32_32x32x16_bf16 v[56:71], v[132:135], v[92:95], v[56:71]
  ds_read_b64_tr_b16 v[80:81], v104 offset:12416
  ds_read_b64_tr_b16 v[82:83], v104 offset:13184
  buffer_load_dwordx4 v[180:183], v2, s[44:47], s93 offen offset:3072 sc1
  s_waitcnt vmcnt(11)
  s_waitcnt lgkmcnt(4)
  v_mfma_f32_32x32x16_bf16 v[24:39], v[72:75], v[136:139], v[24:39]
  ds_read_b64_tr_b16 v[84:85], v104 offset:15360
  ds_read_b64_tr_b16 v[86:87], v104 offset:16128
  s_add_u32 s93, s93, 4096
  buffer_load_dwordx4 v[184:187], v2, s[44:47], s93 offen offset:0 sc1
  s_waitcnt lgkmcnt(4)
  v_mfma_f32_32x32x16_bf16 v[40:55], v[76:79], v[136:139], v[40:55]
  ds_read_b64_tr_b16 v[88:89], v104 offset:15424
  ds_read_b64_tr_b16 v[90:91], v104 offset:16192
  s_waitcnt lgkmcnt(4)
  v_mfma_f32_32x32x16_bf16 v[56:71], v[136:139], v[80:83], v[56:71]
  ds_read_b64_tr_b16 v[92:93], v104 offset:15488
  ds_read_b64_tr_b16 v[94:95], v104 offset:16256
  buffer_load_dwordx4 v[188:191], v2, s[44:47], s93 offen offset:1024 sc1
  s_waitcnt vmcnt(12)
  s_waitcnt lgkmcnt(4)
  v_mfma_f32_32x32x16_bf16 v[24:39], v[84:87], v[140:143], v[24:39]
  ds_read_b64_tr_b16 v[72:73], v104 offset:18432
  ds_read_b64_tr_b16 v[74:75], v104 offset:19200
  buffer_load_dwordx4 v[192:195], v2, s[44:47], s93 offen offset:2048 sc1
  s_waitcnt lgkmcnt(4)
  v_mfma_f32_32x32x16_bf16 v[40:55], v[88:91], v[140:143], v[40:55]
  ds_read_b64_tr_b16 v[76:77], v104 offset:18496
  ds_read_b64_tr_b16 v[78:79], v104 offset:19264
  s_waitcnt lgkmcnt(4)
  v_mfma_f32_32x32x16_bf16 v[56:71], v[140:143], v[92:95], v[56:71]
  ds_read_b64_tr_b16 v[80:81], v104 offset:18560
  ds_read_b64_tr_b16 v[82:83], v104 offset:19328
  buffer_load_dwordx4 v[196:199], v2, s[44:47], s93 offen offset:3072 sc1
  ds_read_b64 v[20:21], v18 offset:8
  s_waitcnt vmcnt(13)
  s_waitcnt lgkmcnt(5)
  v_mfma_f32_32x32x16_bf16 v[24:39], v[72:75], v[144:147], v[24:39]
  ds_read_b64_tr_b16 v[84:85], v104 offset:21504
  ds_read_b64_tr_b16 v[86:87], v104 offset:22272
  s_add_u32 s93, s93, 4096
  buffer_load_dwordx4 v[200:203], v2, s[44:47], s93 offen offset:0 sc1
  s_waitcnt lgkmcnt(5)
  v_mfma_f32_32x32x16_bf16 v[40:55], v[76:79], v[144:147], v[40:55]
  ds_read_b64_tr_b16 v[88:89], v104 offset:21568
  ds_read_b64_tr_b16 v[90:91], v104 offset:22336
  s_waitcnt lgkmcnt(5)
  v_mfma_f32_32x32x16_bf16 v[56:71], v[144:147], v[80:83], v[56:71]
  ds_read_b64_tr_b16 v[92:93], v104 offset:21632
  ds_read_b64_tr_b16 v[94:95], v104 offset:22400
  buffer_load_dwordx4 v[204:207], v2, s[44:47], s93 offen offset:1024 sc1
  s_waitcnt lgkmcnt(6)
  v_min_u32 v20, v20, v21
  v_cmp_gt_u32 vcc, 6, v20
  s_nop 0
  s_cbranch_vccnz adaLN_cond__sliding_local_dilated__glu_gated_geglu__prompt_kernel_g37
adaLN_cond__sliding_local_dilated__glu_gated_geglu__prompt_kernel_h38:
  s_waitcnt vmcnt(14)
  s_waitcnt lgkmcnt(4)
  v_mfma_f32_32x32x16_bf16 v[24:39], v[84:87], v[148:151], v[24:39]
  ds_read_b64_tr_b16 v[72:73], v104 offset:24576
  ds_read_b64_tr_b16 v[74:75], v104 offset:25344
  buffer_load_dwordx4 v[208:211], v2, s[44:47], s93 offen offset:2048 sc1
  s_waitcnt lgkmcnt(4)
  v_mfma_f32_32x32x16_bf16 v[40:55], v[88:91], v[148:151], v[40:55]
  ds_read_b64_tr_b16 v[76:77], v104 offset:24640
  ds_read_b64_tr_b16 v[78:79], v104 offset:25408
  s_waitcnt lgkmcnt(4)
  v_mfma_f32_32x32x16_bf16 v[56:71], v[148:151], v[92:95], v[56:71]
  ds_read_b64_tr_b16 v[80:81], v104 offset:24704
  ds_read_b64_tr_b16 v[82:83], v104 offset:25472
  buffer_load_dwordx4 v[212:215], v2, s[44:47], s93 offen offset:3072 sc1
  s_waitcnt vmcnt(15)
  s_waitcnt lgkmcnt(4)
  v_mfma_f32_32x32x16_bf16 v[24:39], v[72:75], v[152:155], v[24:39]
  ds_read_b64_tr_b16 v[84:85], v104 offset:27648
  ds_read_b64_tr_b16 v[86:87], v104 offset:28416
  s_add_u32 s93, s93, 4096
  buffer_load_dwordx4 v[216:219], v2, s[44:47], s93 offen offset:0 sc1
  s_waitcnt lgkmcnt(4)
  v_mfma_f32_32x32x16_bf16 v[40:55], v[76:79], v[152:155], v[40:55]
  ds_read_b64_tr_b16 v[88:89], v104 offset:27712
  ds_read_b64_tr_b16 v[90:91], v104 offset:28480
  s_waitcnt lgkmcnt(4)
  v_mfma_f32_32x32x16_bf16 v[56:71], v[152:155], v[80:83], v[56:71]
  ds_read_b64_tr_b16 v[92:93], v104 offset:27776
  ds_read_b64_tr_b16 v[94:95], v104 offset:28544
  buffer_load_dwordx4 v[220:223], v2, s[44:47], s93 offen offset:1024 sc1
  s_waitcnt vmcnt(16)
  s_waitcnt lgkmcnt(4)
  v_mfma_f32_32x32x16_bf16 v[24:39], v[84:87], v[156:159], v[24:39]
  ds_read_b64_tr_b16 v[72:73], v104 offset:30720
  ds_read_b64_tr_b16 v[74:75], v104 offset:31488
  buffer_load_dwordx4 v[224:227], v2, s[44:47], s93 offen offset:2048 sc1
  s_waitcnt lgkmcnt(4)
  v_mfma_f32_32x32x16_bf16 v[40:55], v[88:91], v[156:159], v[40:55]
  ds_read_b64_tr_b16 v[76:77], v104 offset:30784
  ds_read_b64_tr_b16 v[78:79], v104 offset:31552
  s_waitcnt lgkmcnt(4)
  v_mfma_f32_32x32x16_bf16 v[56:71], v[156:159], v[92:95], v[56:71]
  ds_read_b64_tr_b16 v[80:81], v104 offset:30848
  ds_read_b64_tr_b16 v[82:83], v104 offset:31616
  buffer_load_dwordx4 v[228:231], v2, s[44:47], s93 offen offset:3072 sc1
  ds_read_b64 v[20:21], v18 offset:8
  s_waitcnt vmcnt(17)
  s_waitcnt lgkmcnt(5)
  v_mfma_f32_32x32x16_bf16 v[24:39], v[72:75], v[160:163], v[24:39]
  ds_read_b64_tr_b16 v[84:85], v104 offset:33792
  ds_read_b64_tr_b16 v[86:87], v104 offset:34560
  s_waitcnt lgkmcnt(5)
  v_mfma_f32_32x32x16_bf16 v[40:55], v[76:79], v[160:163], v[40:55]
  ds_read_b64_tr_b16 v[88:89], v104 offset:33856
  ds_read_b64_tr_b16 v[90:91], v104 offset:34624
  s_waitcnt lgkmcnt(5)
  v_mfma_f32_32x32x16_bf16 v[56:71], v[160:163], v[80:83], v[56:71]
  ds_read_b64_tr_b16 v[92:93], v104 offset:33920
  ds_read_b64_tr_b16 v[94:95], v104 offset:34688
  s_waitcnt lgkmcnt(6)
  v_min_u32 v20, v20, v21
  v_cmp_gt_u32 vcc, 8, v20
  s_nop 0
  s_cbranch_vccnz adaLN_cond__sliding_local_dilated__glu_gated_geglu__prompt_kernel_g39
adaLN_cond__sliding_local_dilated__glu_gated_geglu__prompt_kernel_h40:
  s_waitcnt vmcnt(16)
  s_waitcnt lgkmcnt(4)
  v_mfma_f32_32x32x16_bf16 v[24:39], v[84:87], v[164:167], v[24:39]
  ds_read_b64_tr_b16 v[72:73], v104 offset:36864
  ds_read_b64_tr_b16 v[74:75], v104 offset:37632
  s_waitcnt lgkmcnt(4)
  v_mfma_f32_32x32x16_bf16 v[40:55], v[88:91], v[164:167], v[40:55]
  ds_read_b64_tr_b16 v[76:77], v104 offset:36928
  ds_read_b64_tr_b16 v[78:79], v104 offset:37696
  s_waitcnt lgkmcnt(4)
  v_mfma_f32_32x32x16_bf16 v[56:71], v[164:167], v[92:95], v[56:71]
  ds_read_b64_tr_b16 v[80:81], v104 offset:36992
  ds_read_b64_tr_b16 v[82:83], v104 offset:37760
  s_waitcnt vmcnt(15)
  s_waitcnt lgkmcnt(4)
  v_mfma_f32_32x32x16_bf16 v[24:39], v[72:75], v[168:171], v[24:39]
  ds_read_b64_tr_b16 v[84:85], v104 offset:39936
  ds_read_b64_tr_b16 v[86:87], v104 offset:40704
  s_waitcnt lgkmcnt(4)
  v_mfma_f32_32x32x16_bf16 v[40:55], v[76:79], v[168:171], v[40:55]
  ds_read_b64_tr_b16 v[88:89], v104 offset:40000
  ds_read_b64_tr_b16 v[90:91], v104 offset:40768
  s_waitcnt lgkmcnt(4)
  v_mfma_f32_32x32x16_bf16 v[56:71], v[168:171], v[80:83], v[56:71]
  ds_read_b64_tr_b16 v[92:93], v104 offset:40064
  ds_read_b64_tr_b16 v[94:95], v104 offset:40832
  s_waitcnt vmcnt(14)
  s_waitcnt lgkmcnt(4)
  v_mfma_f32_32x32x16_bf16 v[24:39], v[84:87], v[172:175], v[24:39]
  ds_read_b64_tr_b16 v[72:73], v105 offset:0
  ds_read_b64_tr_b16 v[74:75], v105 offset:768
  s_waitcnt lgkmcnt(4)
  v_mfma_f32_32x32x16_bf16 v[40:55], v[88:91], v[172:175], v[40:55]
  ds_read_b64_tr_b16 v[76:77], v105 offset:64
  ds_read_b64_tr_b16 v[78:79], v105 offset:832
  s_waitcnt lgkmcnt(4)
  v_mfma_f32_32x32x16_bf16 v[56:71], v[172:175], v[92:95], v[56:71]
  ds_read_b64_tr_b16 v[80:81], v105 offset:128
  ds_read_b64_tr_b16 v[82:83], v105 offset:896
  ds_read_b64 v[20:21], v18 offset:8
  s_waitcnt vmcnt(13)
  s_waitcnt lgkmcnt(5)
  v_mfma_f32_32x32x16_bf16 v[24:39], v[72:75], v[176:179], v[24:39]
  ds_read_b64_tr_b16 v[84:85], v105 offset:3072
  ds_read_b64_tr_b16 v[86:87], v105 offset:3840
  s_waitcnt lgkmcnt(5)
  v_mfma_f32_32x32x16_bf16 v[40:55], v[76:79], v[176:179], v[40:55]
  ds_read_b64_tr_b16 v[88:89], v105 offset:3136
  ds_read_b64_tr_b16 v[90:91], v105 offset:3904
  s_waitcnt lgkmcnt(5)
  v_mfma_f32_32x32x16_bf16 v[56:71], v[176:179], v[80:83], v[56:71]
  ds_read_b64_tr_b16 v[92:93], v105 offset:3200
  ds_read_b64_tr_b16 v[94:95], v105 offset:3968
  s_waitcnt lgkmcnt(6)
  v_min_u32 v20, v20, v21
  v_cmp_gt_u32 vcc, 10, v20
  s_nop 0
  s_cbranch_vccnz adaLN_cond__sliding_local_dilated__glu_gated_geglu__prompt_kernel_g41
adaLN_cond__sliding_local_dilated__glu_gated_geglu__prompt_kernel_h42:
  s_waitcnt vmcnt(12)
  s_waitcnt lgkmcnt(4)
  v_mfma_f32_32x32x16_bf16 v[24:39], v[84:87], v[180:183], v[24:39]
  ds_read_b64_tr_b16 v[72:73], v105 offset:6144
  ds_read_b64_tr_b16 v[74:75], v105 offset:6912
  s_waitcnt lgkmcnt(4)
  v_mfma_f32_32x32x16_bf16 v[40:55], v[88:91], v[180:183], v[40:55]
  ds_read_b64_tr_b16 v[76:77], v105 offset:6208
  ds_read_b64_tr_b16 v[78:79], v105 offset:6976
  s_waitcnt lgkmcnt(4)
  v_mfma_f32_32x32x16_bf16 v[56:71], v[180:183], v[92:95], v[56:71]
  ds_read_b64_tr_b16 v[80:81], v105 offset:6272
  ds_read_b64_tr_b16 v[82:83], v105 offset:7040
  s_waitcnt vmcnt(11)
  s_waitcnt lgkmcnt(4)
  v_mfma_f32_32x32x16_bf16 v[24:39], v[72:75], v[184:187], v[24:39]
  ds_read_b64_tr_b16 v[84:85], v105 offset:9216
  ds_read_b64_tr_b16 v[86:87], v105 offset:9984
  s_waitcnt lgkmcnt(4)
  v_mfma_f32_32x32x16_bf16 v[40:55], v[76:79], v[184:187], v[40:55]
  ds_read_b64_tr_b16 v[88:89], v105 offset:9280
  ds_read_b64_tr_b16 v[90:91], v105 offset:10048
  s_waitcnt lgkmcnt(4)
  v_mfma_f32_32x32x16_bf16 v[56:71], v[184:187], v[80:83], v[56:71]
  ds_read_b64_tr_b16 v[92:93], v105 offset:9344
  ds_read_b64_tr_b16 v[94:95], v105 offset:10112
  s_waitcnt vmcnt(10)
  s_waitcnt lgkmcnt(4)
  v_mfma_f32_32x32x16_bf16 v[24:39], v[84:87], v[188:191], v[24:39]
  ds_read_b64_tr_b16 v[72:73], v105 offset:12288
  ds_read_b64_tr_b16 v[74:75], v105 offset:13056
  s_waitcnt lgkmcnt(4)
  v_mfma_f32_32x32x16_bf16 v[40:55], v[88:91], v[188:191], v[40:55]
  ds_read_b64_tr_b16 v[76:77], v105 offset:12352
  ds_read_b64_tr_b16 v[78:79], v105 offset:13120
  s_waitcnt lgkmcnt(4)
  v_mfma_f32_32x32x16_bf16 v[56:71], v[188:191], v[92:95], v[56:71]
  ds_read_b64_tr_b16 v[80:81], v105 offset:12416
  ds_read_b64_tr_b16 v[82:83], v105 offset:13184
  ds_read_b64 v[20:21], v18 offset:8
  s_waitcnt vmcnt(9)
  s_waitcnt lgkmcnt(5)
  v_mfma_f32_32x32x16_bf16 v[24:39], v[72:75], v[192:195], v[24:39]
  ds_read_b64_tr_b16 v[84:85], v105 offset:15360
  ds_read_b64_tr_b16 v[86:87], v105 offset:16128
  s_waitcnt lgkmcnt(5)
  v_mfma_f32_32x32x16_bf16 v[40:55], v[76:79], v[192:195], v[40:55]
  ds_read_b64_tr_b16 v[88:89], v105 offset:15424
  ds_read_b64_tr_b16 v[90:91], v105 offset:16192
  s_waitcnt lgkmcnt(5)
  v_mfma_f32_32x32x16_bf16 v[56:71], v[192:195], v[80:83], v[56:71]
  ds_read_b64_tr_b16 v[92:93], v105 offset:15488
  ds_read_b64_tr_b16 v[94:95], v105 offset:16256
  s_waitcnt lgkmcnt(6)
  v_min_u32 v20, v20, v21
  v_cmp_gt_u32 vcc, 12, v20
  s_nop 0
  s_cbranch_vccnz adaLN_cond__sliding_local_dilated__glu_gated_geglu__prompt_kernel_g43
adaLN_cond__sliding_local_dilated__glu_gated_geglu__prompt_kernel_h44:
  s_waitcnt vmcnt(8)
  s_waitcnt lgkmcnt(4)
  v_mfma_f32_32x32x16_bf16 v[24:39], v[84:87], v[196:199], v[24:39]
  ds_read_b64_tr_b16 v[72:73], v105 offset:18432
  ds_read_b64_tr_b16 v[74:75], v105 offset:19200
  s_waitcnt lgkmcnt(4)
  v_mfma_f32_32x32x16_bf16 v[40:55], v[88:91], v[196:199], v[40:55]
  ds_read_b64_tr_b16 v[76:77], v105 offset:18496
  ds_read_b64_tr_b16 v[78:79], v105 offset:19264
  s_waitcnt lgkmcnt(4)
  v_mfma_f32_32x32x16_bf16 v[56:71], v[196:199], v[92:95], v[56:71]
  ds_read_b64_tr_b16 v[80:81], v105 offset:18560
  ds_read_b64_tr_b16 v[82:83], v105 offset:19328
  s_waitcnt vmcnt(7)
  s_waitcnt lgkmcnt(4)
  v_mfma_f32_32x32x16_bf16 v[24:39], v[72:75], v[200:203], v[24:39]
  ds_read_b64_tr_b16 v[84:85], v105 offset:21504
  ds_read_b64_tr_b16 v[86:87], v105 offset:22272
  s_waitcnt lgkmcnt(4)
  v_mfma_f32_32x32x16_bf16 v[40:55], v[76:79], v[200:203], v[40:55]
  ds_read_b64_tr_b16 v[88:89], v105 offset:21568
  ds_read_b64_tr_b16 v[90:91], v105 offset:22336
  s_waitcnt lgkmcnt(4)
  v_mfma_f32_32x32x16_bf16 v[56:71], v[200:203], v[80:83], v[56:71]
  ds_read_b64_tr_b16 v[92:93], v105 offset:21632
  ds_read_b64_tr_b16 v[94:95], v105 offset:22400
  s_waitcnt vmcnt(6)
  s_waitcnt lgkmcnt(4)
  v_mfma_f32_32x32x16_bf16 v[24:39], v[84:87], v[204:207], v[24:39]
  ds_read_b64_tr_b16 v[72:73], v105 offset:24576
  ds_read_b64_tr_b16 v[74:75], v105 offset:25344
  s_waitcnt lgkmcnt(4)
  v_mfma_f32_32x32x16_bf16 v[40:55], v[88:91], v[204:207], v[40:55]
  ds_read_b64_tr_b16 v[76:77], v105 offset:24640
  ds_read_b64_tr_b16 v[78:79], v105 offset:25408
  s_waitcnt lgkmcnt(4)
  v_mfma_f32_32x32x16_bf16 v[56:71], v[204:207], v[92:95], v[56:71]
  ds_read_b64_tr_b16 v[80:81], v105 offset:24704
  ds_read_b64_tr_b16 v[82:83], v105 offset:25472
  ds_read_b64 v[20:21], v18 offset:8
  s_waitcnt vmcnt(5)
  s_waitcnt lgkmcnt(5)
  v_mfma_f32_32x32x16_bf16 v[24:39], v[72:75], v[208:211], v[24:39]
  ds_read_b64_tr_b16 v[84:85], v105 offset:27648
  ds_read_b64_tr_b16 v[86:87], v105 offset:28416
  s_waitcnt lgkmcnt(5)
  v_mfma_f32_32x32x16_bf16 v[40:55], v[76:79], v[208:211], v[40:55]
  ds_read_b64_tr_b16 v[88:89], v105 offset:27712
  ds_read_b64_tr_b16 v[90:91], v105 offset:28480
  s_waitcnt lgkmcnt(5)
  v_mfma_f32_32x32x16_bf16 v[56:71], v[208:211], v[80:83], v[56:71]
  ds_read_b64_tr_b16 v[92:93], v105 offset:27776
  ds_read_b64_tr_b16 v[94:95], v105 offset:28544
  s_waitcnt lgkmcnt(6)
  v_min_u32 v20, v20, v21
  v_cmp_gt_u32 vcc, 14, v20
  s_nop 0
  s_cbranch_vccnz adaLN_cond__sliding_local_dilated__glu_gated_geglu__prompt_kernel_g45
adaLN_cond__sliding_local_dilated__glu_gated_geglu__prompt_kernel_h46:
  s_waitcnt vmcnt(4)
  s_waitcnt lgkmcnt(4)
  v_mfma_f32_32x32x16_bf16 v[24:39], v[84:87], v[212:215], v[24:39]
  ds_read_b64_tr_b16 v[72:73], v105 offset:30720
  ds_read_b64_tr_b16 v[74:75], v105 offset:31488
  s_waitcnt lgkmcnt(4)
  v_mfma_f32_32x32x16_bf16 v[40:55], v[88:91], v[212:215], v[40:55]
  ds_read_b64_tr_b16 v[76:77], v105 offset:30784
  ds_read_b64_tr_b16 v[78:79], v105 offset:31552
  s_waitcnt lgkmcnt(4)
  v_mfma_f32_32x32x16_bf16 v[56:71], v[212:215], v[92:95], v[56:71]
  ds_read_b64_tr_b16 v[80:81], v105 offset:30848
  ds_read_b64_tr_b16 v[82:83], v105 offset:31616
  s_waitcnt vmcnt(3)
  s_waitcnt lgkmcnt(4)
  v_mfma_f32_32x32x16_bf16 v[24:39], v[72:75], v[216:219], v[24:39]
  ds_read_b64_tr_b16 v[84:85], v105 offset:33792
  ds_read_b64_tr_b16 v[86:87], v105 offset:34560
  s_waitcnt lgkmcnt(4)
  v_mfma_f32_32x32x16_bf16 v[40:55], v[76:79], v[216:219], v[40:55]
  ds_read_b64_tr_b16 v[88:89], v105 offset:33856
  ds_read_b64_tr_b16 v[90:91], v105 offset:34624
  s_waitcnt lgkmcnt(4)
  v_mfma_f32_32x32x16_bf16 v[56:71], v[216:219], v[80:83], v[56:71]
  ds_read_b64_tr_b16 v[92:93], v105 offset:33920
  ds_read_b64_tr_b16 v[94:95], v105 offset:34688
  s_waitcnt vmcnt(2)
  s_waitcnt lgkmcnt(4)
  v_mfma_f32_32x32x16_bf16 v[24:39], v[84:87], v[220:223], v[24:39]
  ds_read_b64_tr_b16 v[72:73], v105 offset:36864
  ds_read_b64_tr_b16 v[74:75], v105 offset:37632
  s_waitcnt lgkmcnt(4)
  v_mfma_f32_32x32x16_bf16 v[40:55], v[88:91], v[220:223], v[40:55]
  ds_read_b64_tr_b16 v[76:77], v105 offset:36928
  ds_read_b64_tr_b16 v[78:79], v105 offset:37696
  s_waitcnt lgkmcnt(4)
  v_mfma_f32_32x32x16_bf16 v[56:71], v[220:223], v[92:95], v[56:71]
  ds_read_b64_tr_b16 v[80:81], v105 offset:36992
  ds_read_b64_tr_b16 v[82:83], v105 offset:37760
  s_waitcnt vmcnt(1)
  s_waitcnt lgkmcnt(4)
  v_mfma_f32_32x32x16_bf16 v[24:39], v[72:75], v[224:227], v[24:39]
  ds_read_b64_tr_b16 v[84:85], v105 offset:39936
  ds_read_b64_tr_b16 v[86:87], v105 offset:40704
  s_waitcnt lgkmcnt(4)
  v_mfma_f32_32x32x16_bf16 v[40:55], v[76:79], v[224:227], v[40:55]
  ds_read_b64_tr_b16 v[88:89], v105 offset:40000
  ds_read_b64_tr_b16 v[90:91], v105 offset:40768
  s_waitcnt lgkmcnt(4)
  v_mfma_f32_32x32x16_bf16 v[56:71], v[224:227], v[80:83], v[56:71]
  ds_read_b64_tr_b16 v[92:93], v105 offset:40064
  ds_read_b64_tr_b16 v[94:95], v105 offset:40832
  s_waitcnt vmcnt(0)
  s_waitcnt lgkmcnt(2)
  v_mfma_f32_32x32x16_bf16 v[40:55], v[88:91], v[228:231], v[40:55]
  s_waitcnt lgkmcnt(0)
  v_mfma_f32_32x32x16_bf16 v[56:71], v[228:231], v[92:95], v[56:71]
  v_mfma_f32_32x32x16_bf16 v[24:39], v[84:87], v[228:231], v[24:39]
  s_lshl_b32 s88, s52, 11
  s_add_u32 s88, s88, 65536
  v_add_u32 v12, s88, v2
  s_nop 5
  v_cvt_pk_bf16_f32 v132, v40, v41
  v_cvt_pk_bf16_f32 v133, v42, v43
  v_cvt_pk_bf16_f32 v134, v44, v45
  v_cvt_pk_bf16_f32 v135, v46, v47
  v_cvt_pk_bf16_f32 v136, v48, v49
  v_cvt_pk_bf16_f32 v137, v50, v51
  v_cvt_pk_bf16_f32 v138, v52, v53
  v_cvt_pk_bf16_f32 v139, v54, v55
  v_cvt_pk_bf16_f32 v142, v56, v57
  v_cvt_pk_bf16_f32 v148, v60, v61
  v_cvt_pk_bf16_f32 v143, v58, v59
  v_cvt_pk_bf16_f32 v149, v62, v63
  v_cvt_pk_bf16_f32 v144, v64, v65
  v_cvt_pk_bf16_f32 v150, v68, v69
  v_cvt_pk_bf16_f32 v145, v66, v67
  v_cvt_pk_bf16_f32 v151, v70, v71
  v_permlane16_swap_b32 v132, v136
  v_permlane16_swap_b32 v133, v137
  v_permlane16_swap_b32 v134, v138
  v_permlane16_swap_b32 v135, v139
  v_permlane32_swap_b32 v144, v150
  v_permlane32_swap_b32 v145, v151
  v_permlane32_swap_b32 v142, v148
  v_permlane32_swap_b32 v143, v149
  v_permlane16_swap_b32 v144, v150
  v_permlane16_swap_b32 v145, v151
  v_permlane16_swap_b32 v142, v148
  v_permlane16_swap_b32 v143, v149
  ds_write_b128 v12, v[136:139] offset:2048
  ds_write_b64 v12, v[144:145] offset:3072
  ds_write_b64 v12, v[150:151] offset:3080
  v_cvt_pk_bf16_f32 v120, v24, v25
  v_cvt_pk_bf16_f32 v121, v26, v27
  v_cvt_pk_bf16_f32 v122, v28, v29
  v_cvt_pk_bf16_f32 v123, v30, v31
  v_cvt_pk_bf16_f32 v124, v32, v33
  v_cvt_pk_bf16_f32 v125, v34, v35
  v_cvt_pk_bf16_f32 v126, v36, v37
  v_cvt_pk_bf16_f32 v127, v38, v39
  v_add_u32 v13, -1, v9
  v_and_b32 v126, v126, v13
  v_and_b32 v127, v127, v13
  v_permlane16_swap_b32 v120, v124
  v_permlane16_swap_b32 v121, v125
  v_permlane16_swap_b32 v122, v126
  v_permlane16_swap_b32 v123, v127
  s_waitcnt lgkmcnt(0)
  s_barrier
  ds_read_b128 v[128:131], v12
  ds_read_b64 v[140:141], v12 offset:1024
  ds_read_b64 v[146:147], v12 offset:1032
  v_mfma_f32_16x16x32_bf16 v[160:163], v[132:135], v[124:127], v[108:111]
  v_mfma_f32_16x16x32_bf16 v[164:167], v[136:139], v[124:127], v[112:115]
  v_mfma_f32_16x16x32_bf16 v[156:159], v[132:135], v[120:123], v[112:115]
  s_waitcnt lgkmcnt(2)
  v_mfma_f32_16x16x32_bf16 v[152:155], v[128:131], v[120:123], v[116:119]
  v_and_b32 v14, 15, v1
  v_lshrrev_b32 v15, 4, v1
  s_mul_i32 s88, s57, 7
  v_add_u32 v15, s88, v15
  v_lshrrev_b32 v12, 1, v15
  v_lshlrev_b32 v12, 9, v12
  v_and_b32 v15, 1, v15
  v_lshl_add_u32 v12, v15, 3, v12
  v_lshl_add_u32 v12, v14, 4, v12
  s_add_u32 s88, s58, s52
  s_sub_u32 s88, s88, 1
  s_lshl_b32 s89, s53, 3
  s_add_u32 s89, s89, s88
  s_mul_i32 s89, s89, 28672
  s_add_u32 s89, s89, 2490368
  s_lshl_b32 s90, s88, 4
  s_add_u32 s90, s90, s57
  s_lshl_b32 s90, s90, 2
  s_add_u32 s90, s90, s56
  s_add_u32 s90, s90, 1536
  s_mov_b32 s91, 0x3e8b97f6
  v_max3_f32 v194, v160, v161, v162
  v_max3_f32 v195, v163, v164, v165
  v_max3_f32 v194, v194, v166, v167
  v_max_f32 v194, v194, v195
  v_max3_f32 v192, v152, v153, v154
  v_max3_f32 v193, v155, v156, v157
  v_max3_f32 v192, v192, v158, v159
  v_max_f32 v192, v192, v193
  v_mov_b32 v195, v194
  v_mov_b32 v193, v192
  s_nop 0
  v_permlane16_swap_b32 v194, v195
  v_permlane16_swap_b32 v192, v193
  v_max_f32 v194, v194, v195
  v_max_f32 v192, v192, v193
  v_mov_b32 v195, v194
  v_mov_b32 v193, v192
  s_nop 0
  v_permlane32_swap_b32 v194, v195
  v_permlane32_swap_b32 v192, v193
  v_max_f32 v194, v194, v195
  v_max_f32 v192, v192, v193
  v_mul_f32 v194, s91, v194
  v_mul_f32 v192, s91, v192
  v_fma_f32 v160, v160, s91, -v194
  v_fma_f32 v161, v161, s91, -v194
  v_fma_f32 v162, v162, s91, -v194
  v_fma_f32 v163, v163, s91, -v194
  v_fma_f32 v164, v164, s91, -v194
  v_fma_f32 v165, v165, s91, -v194
  v_fma_f32 v166, v166, s91, -v194
  v_fma_f32 v167, v167, s91, -v194
  v_fma_f32 v152, v152, s91, -v192
  v_fma_f32 v153, v153, s91, -v192
  v_fma_f32 v154, v154, s91, -v192
  v_fma_f32 v155, v155, s91, -v192
  v_fma_f32 v156, v156, s91, -v192
  v_fma_f32 v157, v157, s91, -v192
  v_fma_f32 v158, v158, s91, -v192
  v_fma_f32 v159, v159, s91, -v192
  v_exp_f32 v160, v160
  v_exp_f32 v161, v161
  v_exp_f32 v162, v162
  v_exp_f32 v163, v163
  v_exp_f32 v164, v164
  v_exp_f32 v165, v165
  v_exp_f32 v166, v166
  v_exp_f32 v167, v167
  v_exp_f32 v152, v152
  v_exp_f32 v153, v153
  v_exp_f32 v154, v154
  v_exp_f32 v155, v155
  v_exp_f32 v156, v156
  v_exp_f32 v157, v157
  v_exp_f32 v158, v158
  v_exp_f32 v159, v159
  v_cvt_pk_bf16_f32 v172, v160, v161
  v_cvt_pk_bf16_f32 v173, v162, v163
  v_cvt_pk_bf16_f32 v174, v164, v165
  v_cvt_pk_bf16_f32 v175, v166, v167
  v_cvt_pk_bf16_f32 v168, v152, v153
  v_cvt_pk_bf16_f32 v169, v154, v155
  v_cvt_pk_bf16_f32 v170, v156, v157
  v_cvt_pk_bf16_f32 v171, v158, v159
  v_mfma_f32_16x16x32_bf16 v[184:187], v[142:145], v[172:175], 0
  v_mfma_f32_16x16x32_bf16 v[188:191], v[148:151], v[172:175], 0
  s_waitcnt lgkmcnt(1)
  v_mfma_f32_16x16x32_bf16 v[176:179], v[140:143], v[168:171], 0
  s_waitcnt lgkmcnt(0)
  v_mfma_f32_16x16x32_bf16 v[180:183], v[146:149], v[168:171], 0
  v_add_f32 v194, v160, v161
  v_add_f32 v195, v162, v163
  v_add_f32 v194, v194, v164
  v_add_f32 v195, v195, v165
  v_add_f32 v192, v152, v153
  v_add_f32 v193, v154, v155
  v_add_f32 v192, v192, v156
  v_add_f32 v193, v193, v157
  v_add_f32 v194, v194, v166
  v_add_f32 v195, v195, v167
  v_add_f32 v194, v194, v195
  v_add_f32 v192, v192, v158
  v_add_f32 v193, v193, v159
  v_add_f32 v192, v192, v193
  v_mov_b32 v195, v194
  v_mov_b32 v193, v192
  s_nop 0
  v_permlane16_swap_b32 v194, v195
  v_permlane16_swap_b32 v192, v193
  v_add_f32 v194, v194, v195
  v_add_f32 v192, v192, v193
  v_mov_b32 v195, v194
  v_mov_b32 v193, v192
  s_nop 0
  v_permlane32_swap_b32 v194, v195
  v_permlane32_swap_b32 v192, v193
  v_add_f32 v194, v194, v195
  v_add_f32 v192, v192, v193
  v_rcp_f32 v194, v194
  v_rcp_f32 v192, v192
  v_pk_mul_f32 v[184:185], v[184:185], v[194:195] op_sel_hi:[1,0]
  v_pk_mul_f32 v[186:187], v[186:187], v[194:195] op_sel_hi:[1,0]
  v_pk_mul_f32 v[188:189], v[188:189], v[194:195] op_sel_hi:[1,0]
  v_pk_mul_f32 v[190:191], v[190:191], v[194:195] op_sel_hi:[1,0]
  v_pk_mul_f32 v[176:177], v[176:177], v[192:193] op_sel_hi:[1,0]
  v_pk_mul_f32 v[178:179], v[178:179], v[192:193] op_sel_hi:[1,0]
  v_pk_mul_f32 v[180:181], v[180:181], v[192:193] op_sel_hi:[1,0]
  v_pk_mul_f32 v[182:183], v[182:183], v[192:193] op_sel_hi:[1,0]
  v_cvt_pk_bf16_f32 v184, v184, v185
  v_cvt_pk_bf16_f32 v185, v186, v187
  v_cvt_pk_bf16_f32 v188, v188, v189
  v_cvt_pk_bf16_f32 v189, v190, v191
  v_cvt_pk_bf16_f32 v176, v176, v177
  v_cvt_pk_bf16_f32 v177, v178, v179
  v_cvt_pk_bf16_f32 v180, v180, v181
  v_cvt_pk_bf16_f32 v181, v182, v183
  s_cmp_lg_u32 s55, 0
  s_cbranch_scc1 adaLN_cond__sliding_local_dilated__glu_gated_geglu__prompt_kernel_m47
  buffer_store_dwordx2 v[184:185], v12, s[44:47], s89 offen offset:256
  buffer_store_dwordx2 v[176:177], v12, s[44:47], s89 offen offset:0
  s_mov_b32 exec_hi, 0xffff
  buffer_store_dwordx2 v[188:189], v12, s[44:47], s89 offen offset:1280
  buffer_store_dwordx2 v[180:181], v12, s[44:47], s89 offen offset:1024
  s_waitcnt vmcnt(0)
  s_mov_b64 exec, 1
  buffer_store_dword v4, off, s[44:47], s90
  s_mov_b64 exec, -1
adaLN_cond__sliding_local_dilated__glu_gated_geglu__prompt_kernel_e48:
  s_cmp_ge_u32 s50, 28
  s_cbranch_scc1 L_fin
  s_cmp_ge_u32 s50, 16
  s_cbranch_scc1 L_chm
  s_barrier
  v_lshrrev_b32 v12, 3, v1
  v_mul_u32_u24 v13, 3584, v12
  v_and_b32 v12, 2, v12
  v_and_b32 v14, 7, v1
  v_xor_b32 v14, v14, v12
  v_lshl_add_u32 v24, v14, 4, v13
  v_xor_b32 v14, 4, v14
  v_lshl_add_u32 v25, v14, 4, v13
  s_lshl_b32 s88, s51, 7
  v_add_u32 v24, s88, v24
  v_add_u32 v25, s88, v25
  v_lshl_add_u32 v13, v9, 2, v10
  v_lshlrev_b32 v13, 7, v13
  v_lshl_add_u32 v13, v11, 3, v13
  v_lshrrev_b32 v12, 1, v10
  v_lshl_add_u32 v15, v16, 1, v12
  v_lshlrev_b32 v14, 13, v16
  v_add_u32 v14, v13, v14
  v_lshl_add_u32 v27, v15, 5, v14
  v_xor_b32 v28, 32, v27
  v_xor_b32 v29, 64, v27
  v_xor_b32 v30, 96, v27
  s_and_b32 s88, s63, 1
  v_xor_b32 v12, s88, v12
  v_lshl_add_u32 v13, v12, 6, v13
  v_lshl_add_u32 v13, v16, 5, v13
  s_lshl_b32 s88, s63, 11
  v_add_u32 v31, s88, v13
  v_xor_b32 v34, 64, v31
  v_add_u32 v32, 57344, v31
  v_add_u32 v33, 114688, v31
  v_add_u32 v35, 57344, v34
  v_add_u32 v36, 114688, v34
  v_lshrrev_b32 v12, 3, v1
  v_mul_u32_u24 v26, 896, v12
  v_lshlrev_b32 v12, 1, v12
  v_and_b32 v12, 4, v12
  v_and_b32 v13, 7, v1
  v_xor_b32 v13, v13, v12
  v_lshl_add_u32 v26, v13, 4, v26
  s_lshl_b32 s88, s60, 7
  v_add_u32 v26, s88, v26
  s_branch L_free
L_chm:
  v_lshrrev_b32 v12, 3, v1
  v_mul_u32_u24 v13, 3584, v12
  v_and_b32 v12, 2, v12
  v_and_b32 v14, 7, v1
  v_xor_b32 v14, v14, v12
  v_lshl_add_u32 v24, v14, 4, v13
  v_xor_b32 v14, 4, v14
  v_lshl_add_u32 v25, v14, 4, v13
  s_lshl_b32 s88, s51, 7
  v_add_u32 v24, s88, v24
  v_add_u32 v25, s88, v25
  v_lshl_add_u32 v13, v9, 2, v10
  v_lshlrev_b32 v13, 7, v13
  v_lshl_add_u32 v13, v11, 3, v13
  v_lshrrev_b32 v12, 1, v10
  v_lshl_add_u32 v15, v16, 1, v12
  v_lshlrev_b32 v14, 13, v16
  v_add_u32 v14, v13, v14
  v_lshl_add_u32 v27, v15, 5, v14
  v_xor_b32 v28, 32, v27
  v_xor_b32 v29, 64, v27
  v_xor_b32 v30, 96, v27
  s_and_b32 s88, s63, 1
  v_xor_b32 v12, s88, v12
  v_lshl_add_u32 v13, v12, 6, v13
  v_lshl_add_u32 v13, v16, 5, v13
  s_lshl_b32 s88, s63, 11
  v_add_u32 v31, s88, v13
  v_xor_b32 v34, 64, v31
  v_add_u32 v32, 57344, v31
  v_add_u32 v33, 114688, v31
  v_add_u32 v35, 57344, v34
  v_add_u32 v36, 114688, v34
  v_lshrrev_b32 v12, 3, v1
  v_mul_u32_u24 v26, 896, v12
  v_lshlrev_b32 v12, 1, v12
  v_and_b32 v12, 4, v12
  v_and_b32 v13, 7, v1
  v_xor_b32 v13, v13, v12
  v_lshl_add_u32 v26, v13, 4, v26
  s_lshl_b32 s88, s60, 7
  v_add_u32 v26, s88, v26
  s_barrier
  s_and_b32 s91, s52, 3
  s_mul_i32 s89, s91, 28672
  s_lshl_b32 s88, s91, 10
  s_add_u32 m0, s88, 32768
  s_add_u32 s90, s89, 458752
  buffer_load_dwordx4 v24, s[16:19], s90 offen lds
  s_waitcnt vmcnt(3)
  s_add_u32 m0, s88, 36864
  s_add_u32 s90, s89, 573440
  buffer_load_dwordx4 v24, s[16:19], s90 offen lds
  s_waitcnt vmcnt(3)
  s_add_u32 m0, s88, 40960
  s_add_u32 s90, s89, 458752
  buffer_load_dwordx4 v25, s[20:23], s90 offen lds
  s_waitcnt vmcnt(3)
  s_add_u32 m0, s88, 45056
  s_add_u32 s90, s89, 573440
  buffer_load_dwordx4 v25, s[20:23], s90 offen lds
  s_waitcnt vmcnt(3)
  s_add_u32 m0, s88, 49152
  s_add_u32 s90, s89, 688128
  buffer_load_dwordx4 v24, s[16:19], s90 offen lds
  s_waitcnt vmcnt(3)
  s_add_u32 m0, s88, 53248
  s_add_u32 s90, s89, 802816
  buffer_load_dwordx4 v24, s[16:19], s90 offen lds
  s_waitcnt vmcnt(3)
  s_add_u32 m0, s88, 57344
  s_add_u32 s90, s89, 688128
  buffer_load_dwordx4 v25, s[20:23], s90 offen lds
  s_waitcnt vmcnt(3)
  s_add_u32 m0, s88, 61440
  s_add_u32 s90, s89, 802816
  buffer_load_dwordx4 v25, s[20:23], s90 offen lds
  s_waitcnt vmcnt(3)
  s_add_u32 m0, s88, 65536
  s_add_u32 s90, s89, 917504
  buffer_load_dwordx4 v24, s[16:19], s90 offen lds
  s_waitcnt vmcnt(3)
  s_add_u32 m0, s88, 69632
  s_add_u32 s90, s89, 1032192
  buffer_load_dwordx4 v24, s[16:19], s90 offen lds
  s_waitcnt vmcnt(3)
  s_add_u32 m0, s88, 73728
  s_add_u32 s90, s89, 917504
  buffer_load_dwordx4 v25, s[20:23], s90 offen lds
  s_waitcnt vmcnt(3)
  s_add_u32 m0, s88, 77824
  s_add_u32 s90, s89, 1032192
  buffer_load_dwordx4 v25, s[20:23], s90 offen lds
  s_waitcnt vmcnt(3)
  s_add_u32 m0, s88, 81920
  s_add_u32 s90, s89, 1146880
  buffer_load_dwordx4 v24, s[16:19], s90 offen lds
  s_waitcnt vmcnt(3)
  s_add_u32 m0, s88, 86016
  s_add_u32 s90, s89, 1261568
  buffer_load_dwordx4 v24, s[16:19], s90 offen lds
  s_waitcnt vmcnt(3)
  s_add_u32 m0, s88, 90112
  s_add_u32 s90, s89, 1146880
  buffer_load_dwordx4 v25, s[20:23], s90 offen lds
  s_waitcnt vmcnt(3)
  s_add_u32 m0, s88, 94208
  s_add_u32 s90, s89, 1261568
  buffer_load_dwordx4 v25, s[20:23], s90 offen lds
  s_waitcnt vmcnt(3)
  s_branch L_p3
L_free:
  s_lshl_b32 s91, s50, 3
  s_add_u32 s91, s91, s52
  s_mul_i32 s89, s91, 30
  v_add_u32 v12, s89, v1
  v_mul_u32_u24 v13, 43691, v12
  v_lshrrev_b32 v13, 19, v13
  v_mul_u32_u24 v14, 12, v13
  v_sub_u32 v12, v12, v14
  s_mul_i32 s89, s53, 7
  s_lshr_b32 s89, s89, 1
  s_add_u32 s89, s89, 16
  v_add_u32 v12, s89, v12
  v_subrev_u32 v14, 28, v12
  v_min_u32 v12, v12, v14
  v_mul_u32_u24 v13, 3584, v13
  v_lshl_add_u32 v12, v12, 7, v13
  s_mov_b32 s89, 458752
  s_nop 4
  s_mov_b32 exec_lo, 1073741823
  s_mov_b32 exec_hi, 0
  buffer_load_dword v255, v12, s[16:19], s89 offen
  buffer_load_dword v255, v12, s[20:23], s89 offen
  s_mov_b64 exec, -1
  s_barrier
  s_lshl_b32 s85, s52, 10
  s_mul_i32 s84, s52, 28672
  s_add_u32 m0, s85, 32768
  s_add_u32 s88, s84, 458752
  buffer_load_dwordx4 v24, s[16:19], s88 offen lds
  s_add_u32 m0, s85, 40960
  s_add_u32 s88, s84, 458752
  buffer_load_dwordx4 v25, s[20:23], s88 offen lds
  s_add_u32 m0, s85, 49152
  s_add_u32 s88, s84, 688128
  buffer_load_dwordx4 v24, s[16:19], s88 offen lds
  s_add_u32 m0, s85, 57344
  s_add_u32 s88, s84, 688128
  buffer_load_dwordx4 v25, s[20:23], s88 offen lds
  s_add_u32 m0, s85, 65536
  s_add_u32 s88, s84, 917504
  buffer_load_dwordx4 v24, s[16:19], s88 offen lds
  s_add_u32 m0, s85, 73728
  s_add_u32 s88, s84, 917504
  buffer_load_dwordx4 v25, s[20:23], s88 offen lds
  s_add_u32 m0, s85, 81920
  s_add_u32 s88, s84, 1146880
  buffer_load_dwordx4 v24, s[16:19], s88 offen lds
  s_add_u32 m0, s85, 90112
  s_add_u32 s88, s84, 1146880
  buffer_load_dwordx4 v25, s[20:23], s88 offen lds
  v_mul_u32_u24 v12, 3584, v1
  s_lshl_b32 s88, s51, 7
  s_cmp_lg_u32 s52, 0
  s_cbranch_scc1 adaLN_cond__sliding_local_dilated__glu_gated_geglu__prompt_kernel_q49
  s_add_u32 s88, s88, 1376256
  buffer_load_dword v255, v12, s[16:19], s88 offen
adaLN_cond__sliding_local_dilated__glu_gated_geglu__prompt_kernel_q49:
  s_cmp_lg_u32 s52, 1
  s_cbranch_scc1 adaLN_cond__sliding_local_dilated__glu_gated_geglu__prompt_kernel_q50
  s_add_u32 s88, s88, 1376256
  buffer_load_dword v255, v12, s[20:23], s88 offen
adaLN_cond__sliding_local_dilated__glu_gated_geglu__prompt_kernel_q50:
L_p3:
  s_mov_b32 s91, 0
L_p3x:
  s_lshl_b32 s92, s53, 3
  s_add_u32 s92, s92, s62
  s_mul_i32 s95, s63, 401408
  s_and_b32 s88, s52, 1
  s_mul_i32 s88, s88, 7168
  s_add_u32 s95, s95, s88
  s_lshl_b32 s85, s52, 10
  s_mul_i32 s84, s52, 28672
  s_lshl_b32 s88, s53, 3
  s_add_u32 s88, s88, s52
  s_add_u32 s93, s52, 1
  s_cmp_eq_u32 s93, 4
  s_cselect_b32 s93, 0, s93
  s_mul_i32 s93, s93, 28672
  s_add_u32 s93, s93, s61
  s_mul_i32 s96, s88, 114688
  s_lshl_b32 s89, s51, 12
  s_add_u32 s96, s96, s89
  s_add_u32 s96, s96, 6160384
  s_lshl_b32 s94, s52, 7
  s_add_u32 s94, s94, s56
  s_add_u32 s89, s94, 2048
  s_cmp_lg_u32 s91, 0
  s_cbranch_scc1 L_nw3
  s_waitcnt vmcnt(0)
L_nw3:
  s_barrier
  ds_read_b64_tr_b16 v[40:41], v27 offset:0
  ds_read_b64_tr_b16 v[42:43], v27 offset:1024
  ds_read_b64_tr_b16 v[44:45], v28 offset:0
  ds_read_b64_tr_b16 v[46:47], v28 offset:1024
  ds_read_b64_tr_b16 v[48:49], v29 offset:0
  ds_read_b64_tr_b16 v[50:51], v29 offset:1024
  ds_read_b64_tr_b16 v[52:53], v30 offset:0
  ds_read_b64_tr_b16 v[54:55], v30 offset:1024
  v_min_u32 v3, 6, v1
  v_lshlrev_b32 v3, 2, v3
  s_mov_b32 s99, 262144
adaLN_cond__sliding_local_dilated__glu_gated_geglu__prompt_kernel_p51:
  buffer_load_dword v8, v3, s[44:47], s89 offen sc1
  s_waitcnt vmcnt(0)
  v_cmp_ne_u32 vcc, 1, v8
  s_sub_u32 s99, s99, 1
  s_cbranch_scc1 adaLN_cond__sliding_local_dilated__glu_gated_geglu__prompt_kernel_d52
  s_cbranch_vccnz adaLN_cond__sliding_local_dilated__glu_gated_geglu__prompt_kernel_p51
adaLN_cond__sliding_local_dilated__glu_gated_geglu__prompt_kernel_d52:
  s_cmp_lt_u32 s52, 4
  s_cbranch_scc1 L_np
  s_setprio 1
L_np:
  buffer_load_dwordx4 v[136:139], v2, s[44:47], s93 offen offset:0 sc1
  buffer_load_dwordx4 v[140:143], v2, s[44:47], s93 offen offset:1024 sc1
  buffer_load_dwordx4 v[144:147], v2, s[44:47], s93 offen offset:2048 sc1
  buffer_load_dwordx4 v[148:151], v2, s[44:47], s93 offen offset:3072 sc1
  s_cmp_eq_u32 s91, 0
  s_cbranch_scc1 L_nx1
  s_cmp_lg_u32 s55, 0
  s_cbranch_scc1 adaLN_cond__sliding_local_dilated__glu_gated_geglu__prompt_kernel_m53
  s_mov_b64 exec, 1
  buffer_store_dword v4, off, s[44:47], s91
  s_mov_b64 exec, -1
adaLN_cond__sliding_local_dilated__glu_gated_geglu__prompt_kernel_e54:
L_nx1:
  v_mov_b32 v12, 0xc0135761
  v_mov_b32 v13, 0xc0135761
  v_mov_b32 v14, 0xbdd2d3e8
  v_mov_b32 v15, 0xbdd2d3e8
  s_lshl_b32 s90, s51, 2
  s_add_u32 s94, s94, s90
  s_add_u32 s94, s94, 3072
  s_waitcnt vmcnt(3)
  s_waitcnt lgkmcnt(6)
  v_mfma_f32_32x32x16_bf16 v[72:87], v[40:43], v[136:139], 0
  ds_read_b64_tr_b16 v[56:57], v27 offset:2048
  ds_read_b64_tr_b16 v[58:59], v27 offset:3072
  s_add_u32 s93, s93, 4096
  buffer_load_dwordx4 v[152:155], v2, s[44:47], s93 offen offset:0 sc1
  s_waitcnt lgkmcnt(6)
  v_mfma_f32_32x32x16_bf16 v[88:103], v[44:47], v[136:139], 0
  ds_read_b64_tr_b16 v[60:61], v28 offset:2048
  ds_read_b64_tr_b16 v[62:63], v28 offset:3072
  s_waitcnt lgkmcnt(6)
  v_mfma_f32_32x32x16_bf16 v[104:119], v[48:51], v[136:139], 0
  ds_read_b64_tr_b16 v[64:65], v29 offset:2048
  ds_read_b64_tr_b16 v[66:67], v29 offset:3072
  buffer_load_dwordx4 v[156:159], v2, s[44:47], s93 offen offset:1024 sc1
  s_waitcnt lgkmcnt(6)
  v_mfma_f32_32x32x16_bf16 v[120:135], v[52:55], v[136:139], 0
  ds_read_b64_tr_b16 v[68:69], v30 offset:2048
  ds_read_b64_tr_b16 v[70:71], v30 offset:3072
  s_waitcnt vmcnt(4)
  s_waitcnt lgkmcnt(6)
  v_mfma_f32_32x32x16_bf16 v[72:87], v[56:59], v[140:143], v[72:87]
  ds_read_b64_tr_b16 v[40:41], v27 offset:4096
  ds_read_b64_tr_b16 v[42:43], v27 offset:5120
  buffer_load_dwordx4 v[160:163], v2, s[44:47], s93 offen offset:2048 sc1
  s_waitcnt lgkmcnt(6)
  v_mfma_f32_32x32x16_bf16 v[88:103], v[60:63], v[140:143], v[88:103]
  ds_read_b64_tr_b16 v[44:45], v28 offset:4096
  ds_read_b64_tr_b16 v[46:47], v28 offset:5120
  s_waitcnt lgkmcnt(6)
  v_mfma_f32_32x32x16_bf16 v[104:119], v[64:67], v[140:143], v[104:119]
  ds_read_b64_tr_b16 v[48:49], v29 offset:4096
  ds_read_b64_tr_b16 v[50:51], v29 offset:5120
  buffer_load_dwordx4 v[164:167], v2, s[44:47], s93 offen offset:3072 sc1
  s_waitcnt lgkmcnt(6)
  v_mfma_f32_32x32x16_bf16 v[120:135], v[68:71], v[140:143], v[120:135]
  ds_read_b64_tr_b16 v[52:53], v30 offset:4096
  ds_read_b64_tr_b16 v[54:55], v30 offset:5120
  s_waitcnt vmcnt(5)
  s_waitcnt lgkmcnt(6)
  v_mfma_f32_32x32x16_bf16 v[72:87], v[40:43], v[144:147], v[72:87]
  ds_read_b64_tr_b16 v[56:57], v27 offset:6144
  ds_read_b64_tr_b16 v[58:59], v27 offset:7168
  s_add_u32 s93, s93, 4096
  buffer_load_dwordx4 v[168:171], v2, s[44:47], s93 offen offset:0 sc1
  s_waitcnt lgkmcnt(6)
  v_mfma_f32_32x32x16_bf16 v[88:103], v[44:47], v[144:147], v[88:103]
  ds_read_b64_tr_b16 v[60:61], v28 offset:6144
  ds_read_b64_tr_b16 v[62:63], v28 offset:7168
  s_waitcnt lgkmcnt(6)
  v_mfma_f32_32x32x16_bf16 v[104:119], v[48:51], v[144:147], v[104:119]
  ds_read_b64_tr_b16 v[64:65], v29 offset:6144
  ds_read_b64_tr_b16 v[66:67], v29 offset:7168
  buffer_load_dwordx4 v[172:175], v2, s[44:47], s93 offen offset:1024 sc1
  s_waitcnt lgkmcnt(6)
  v_mfma_f32_32x32x16_bf16 v[120:135], v[52:55], v[144:147], v[120:135]
  ds_read_b64_tr_b16 v[68:69], v30 offset:6144
  ds_read_b64_tr_b16 v[70:71], v30 offset:7168
  s_waitcnt vmcnt(6)
  s_waitcnt lgkmcnt(6)
  v_mfma_f32_32x32x16_bf16 v[72:87], v[56:59], v[148:151], v[72:87]
  ds_read_b64_tr_b16 v[40:41], v27 offset:16384
  ds_read_b64_tr_b16 v[42:43], v27 offset:17408
  buffer_load_dwordx4 v[176:179], v2, s[44:47], s93 offen offset:2048 sc1
  s_waitcnt lgkmcnt(6)
  v_mfma_f32_32x32x16_bf16 v[88:103], v[60:63], v[148:151], v[88:103]
  ds_read_b64_tr_b16 v[44:45], v28 offset:16384
  ds_read_b64_tr_b16 v[46:47], v28 offset:17408
  s_waitcnt lgkmcnt(6)
  v_mfma_f32_32x32x16_bf16 v[104:119], v[64:67], v[148:151], v[104:119]
  ds_read_b64_tr_b16 v[48:49], v29 offset:16384
  ds_read_b64_tr_b16 v[50:51], v29 offset:17408
  buffer_load_dwordx4 v[180:183], v2, s[44:47], s93 offen offset:3072 sc1
  s_waitcnt lgkmcnt(6)
  v_mfma_f32_32x32x16_bf16 v[120:135], v[68:71], v[148:151], v[120:135]
  ds_read_b64_tr_b16 v[52:53], v30 offset:16384
  ds_read_b64_tr_b16 v[54:55], v30 offset:17408
  s_waitcnt vmcnt(7)
  s_waitcnt lgkmcnt(6)
  v_mfma_f32_32x32x16_bf16 v[72:87], v[40:43], v[152:155], v[72:87]
  ds_read_b64_tr_b16 v[56:57], v27 offset:18432
  ds_read_b64_tr_b16 v[58:59], v27 offset:19456
  s_add_u32 s93, s93, 4096
  buffer_load_dwordx4 v[184:187], v2, s[44:47], s93 offen offset:0 sc1
  s_waitcnt lgkmcnt(6)
  v_mfma_f32_32x32x16_bf16 v[88:103], v[44:47], v[152:155], v[88:103]
  ds_read_b64_tr_b16 v[60:61], v28 offset:18432
  ds_read_b64_tr_b16 v[62:63], v28 offset:19456
  s_waitcnt lgkmcnt(6)
  v_mfma_f32_32x32x16_bf16 v[104:119], v[48:51], v[152:155], v[104:119]
  ds_read_b64_tr_b16 v[64:65], v29 offset:18432
  ds_read_b64_tr_b16 v[66:67], v29 offset:19456
  buffer_load_dwordx4 v[188:191], v2, s[44:47], s93 offen offset:1024 sc1
  s_waitcnt lgkmcnt(6)
  v_mfma_f32_32x32x16_bf16 v[120:135], v[52:55], v[152:155], v[120:135]
  ds_read_b64_tr_b16 v[68:69], v30 offset:18432
  ds_read_b64_tr_b16 v[70:71], v30 offset:19456
  s_waitcnt vmcnt(8)
  s_waitcnt lgkmcnt(6)
  v_mfma_f32_32x32x16_bf16 v[72:87], v[56:59], v[156:159], v[72:87]
  ds_read_b64_tr_b16 v[40:41], v27 offset:20480
  ds_read_b64_tr_b16 v[42:43], v27 offset:21504
  buffer_load_dwordx4 v[192:195], v2, s[44:47], s93 offen offset:2048 sc1
  s_waitcnt lgkmcnt(6)
  v_mfma_f32_32x32x16_bf16 v[88:103], v[60:63], v[156:159], v[88:103]
  ds_read_b64_tr_b16 v[44:45], v28 offset:20480
  ds_read_b64_tr_b16 v[46:47], v28 offset:21504
  s_waitcnt lgkmcnt(6)
  v_mfma_f32_32x32x16_bf16 v[104:119], v[64:67], v[156:159], v[104:119]
  ds_read_b64_tr_b16 v[48:49], v29 offset:20480
  ds_read_b64_tr_b16 v[50:51], v29 offset:21504
  buffer_load_dwordx4 v[196:199], v2, s[44:47], s93 offen offset:3072 sc1
  s_waitcnt lgkmcnt(6)
  v_mfma_f32_32x32x16_bf16 v[120:135], v[68:71], v[156:159], v[120:135]
  ds_read_b64_tr_b16 v[52:53], v30 offset:20480
  ds_read_b64_tr_b16 v[54:55], v30 offset:21504
  s_waitcnt vmcnt(9)
  s_waitcnt lgkmcnt(6)
  v_mfma_f32_32x32x16_bf16 v[72:87], v[40:43], v[160:163], v[72:87]
  ds_read_b64_tr_b16 v[56:57], v27 offset:22528
  ds_read_b64_tr_b16 v[58:59], v27 offset:23552
  s_add_u32 s93, s93, 4096
  buffer_load_dwordx4 v[200:203], v2, s[44:47], s93 offen offset:0 sc1
  s_waitcnt lgkmcnt(6)
  v_mfma_f32_32x32x16_bf16 v[88:103], v[44:47], v[160:163], v[88:103]
  ds_read_b64_tr_b16 v[60:61], v28 offset:22528
  ds_read_b64_tr_b16 v[62:63], v28 offset:23552
  s_waitcnt lgkmcnt(6)
  v_mfma_f32_32x32x16_bf16 v[104:119], v[48:51], v[160:163], v[104:119]
  ds_read_b64_tr_b16 v[64:65], v29 offset:22528
  ds_read_b64_tr_b16 v[66:67], v29 offset:23552
  buffer_load_dwordx4 v[204:207], v2, s[44:47], s93 offen offset:1024 sc1
  s_waitcnt lgkmcnt(6)
  v_mfma_f32_32x32x16_bf16 v[120:135], v[52:55], v[160:163], v[120:135]
  ds_read_b64_tr_b16 v[68:69], v30 offset:22528
  ds_read_b64_tr_b16 v[70:71], v30 offset:23552
  s_waitcnt vmcnt(10)
  s_waitcnt lgkmcnt(6)
  v_mfma_f32_32x32x16_bf16 v[72:87], v[56:59], v[164:167], v[72:87]
  ds_read_b64_tr_b16 v[40:41], v27 offset:32768
  ds_read_b64_tr_b16 v[42:43], v27 offset:33792
  buffer_load_dwordx4 v[208:211], v2, s[44:47], s93 offen offset:2048 sc1
  s_waitcnt lgkmcnt(6)
  v_mfma_f32_32x32x16_bf16 v[88:103], v[60:63], v[164:167], v[88:103]
  ds_read_b64_tr_b16 v[44:45], v28 offset:32768
  ds_read_b64_tr_b16 v[46:47], v28 offset:33792
  s_waitcnt lgkmcnt(6)
  v_mfma_f32_32x32x16_bf16 v[104:119], v[64:67], v[164:167], v[104:119]
  ds_read_b64_tr_b16 v[48:49], v29 offset:32768
  ds_read_b64_tr_b16 v[50:51], v29 offset:33792
  s_add_u32 m0, s85, 98304
  s_add_u32 s88, s84, 1376256
  buffer_load_dwordx4 v24, s[16:19], s88 offen lds
  s_waitcnt lgkmcnt(6)
  v_mfma_f32_32x32x16_bf16 v[120:135], v[68:71], v[164:167], v[120:135]
  ds_read_b64_tr_b16 v[52:53], v30 offset:32768
  ds_read_b64_tr_b16 v[54:55], v30 offset:33792
  s_waitcnt vmcnt(11)
  s_waitcnt lgkmcnt(6)
  v_mfma_f32_32x32x16_bf16 v[72:87], v[40:43], v[168:171], v[72:87]
  ds_read_b64_tr_b16 v[56:57], v27 offset:34816
  ds_read_b64_tr_b16 v[58:59], v27 offset:35840
  s_add_u32 m0, s85, 106496
  s_add_u32 s88, s84, 1376256
  buffer_load_dwordx4 v25, s[20:23], s88 offen lds
  s_waitcnt lgkmcnt(6)
  v_mfma_f32_32x32x16_bf16 v[88:103], v[44:47], v[168:171], v[88:103]
  ds_read_b64_tr_b16 v[60:61], v28 offset:34816
  ds_read_b64_tr_b16 v[62:63], v28 offset:35840
  s_waitcnt lgkmcnt(6)
  v_mfma_f32_32x32x16_bf16 v[104:119], v[48:51], v[168:171], v[104:119]
  ds_read_b64_tr_b16 v[64:65], v29 offset:34816
  ds_read_b64_tr_b16 v[66:67], v29 offset:35840
  buffer_load_dwordx4 v[212:215], v2, s[44:47], s93 offen offset:3072 sc1
  s_waitcnt lgkmcnt(6)
  v_mfma_f32_32x32x16_bf16 v[120:135], v[52:55], v[168:171], v[120:135]
  ds_read_b64_tr_b16 v[68:69], v30 offset:34816
  ds_read_b64_tr_b16 v[70:71], v30 offset:35840
  s_waitcnt vmcnt(12)
  s_waitcnt lgkmcnt(6)
  v_mfma_f32_32x32x16_bf16 v[72:87], v[56:59], v[172:175], v[72:87]
  ds_read_b64_tr_b16 v[40:41], v27 offset:36864
  ds_read_b64_tr_b16 v[42:43], v27 offset:37888
  s_add_u32 s93, s93, 4096
  buffer_load_dwordx4 v[216:219], v2, s[44:47], s93 offen offset:0 sc1
  s_waitcnt lgkmcnt(6)
  v_mfma_f32_32x32x16_bf16 v[88:103], v[60:63], v[172:175], v[88:103]
  ds_read_b64_tr_b16 v[44:45], v28 offset:36864
  ds_read_b64_tr_b16 v[46:47], v28 offset:37888
  s_waitcnt lgkmcnt(6)
  v_mfma_f32_32x32x16_bf16 v[104:119], v[64:67], v[172:175], v[104:119]
  ds_read_b64_tr_b16 v[48:49], v29 offset:36864
  ds_read_b64_tr_b16 v[50:51], v29 offset:37888
  buffer_load_dwordx4 v[220:223], v2, s[44:47], s93 offen offset:1024 sc1
  s_waitcnt lgkmcnt(6)
  v_mfma_f32_32x32x16_bf16 v[120:135], v[68:71], v[172:175], v[120:135]
  ds_read_b64_tr_b16 v[52:53], v30 offset:36864
  ds_read_b64_tr_b16 v[54:55], v30 offset:37888
  s_waitcnt vmcnt(13)
  s_waitcnt lgkmcnt(6)
  v_mfma_f32_32x32x16_bf16 v[72:87], v[40:43], v[176:179], v[72:87]
  ds_read_b64_tr_b16 v[56:57], v27 offset:38912
  ds_read_b64_tr_b16 v[58:59], v27 offset:39936
  buffer_load_dwordx4 v[224:227], v2, s[44:47], s93 offen offset:2048 sc1
  s_waitcnt lgkmcnt(6)
  v_mfma_f32_32x32x16_bf16 v[88:103], v[44:47], v[176:179], v[88:103]
  ds_read_b64_tr_b16 v[60:61], v28 offset:38912
  ds_read_b64_tr_b16 v[62:63], v28 offset:39936
  s_waitcnt lgkmcnt(6)
  v_mfma_f32_32x32x16_bf16 v[104:119], v[48:51], v[176:179], v[104:119]
  ds_read_b64_tr_b16 v[64:65], v29 offset:38912
  ds_read_b64_tr_b16 v[66:67], v29 offset:39936
  buffer_load_dwordx4 v[228:231], v2, s[44:47], s93 offen offset:3072 sc1
  s_waitcnt lgkmcnt(6)
  v_mfma_f32_32x32x16_bf16 v[120:135], v[52:55], v[176:179], v[120:135]
  ds_read_b64_tr_b16 v[68:69], v30 offset:38912
  ds_read_b64_tr_b16 v[70:71], v30 offset:39936
  s_waitcnt vmcnt(14)
  s_waitcnt lgkmcnt(6)
  v_mfma_f32_32x32x16_bf16 v[72:87], v[56:59], v[180:183], v[72:87]
  v_add_u32 v27, 49152, v27
  ds_read_b64_tr_b16 v[40:41], v27 offset:0
  ds_read_b64_tr_b16 v[42:43], v27 offset:1024
  s_add_u32 s93, s93, 4096
  buffer_load_dwordx4 v[232:235], v2, s[44:47], s93 offen offset:0 sc1
  s_waitcnt lgkmcnt(6)
  v_mfma_f32_32x32x16_bf16 v[88:103], v[60:63], v[180:183], v[88:103]
  ds_read_b64_tr_b16 v[44:45], v27 offset:2048
  ds_read_b64_tr_b16 v[46:47], v27 offset:3072
  s_waitcnt lgkmcnt(6)
  v_mfma_f32_32x32x16_bf16 v[104:119], v[64:67], v[180:183], v[104:119]
  ds_read_b64_tr_b16 v[48:49], v27 offset:4096
  ds_read_b64_tr_b16 v[50:51], v27 offset:5120
  buffer_load_dwordx4 v[236:239], v2, s[44:47], s93 offen offset:1024 sc1
  s_waitcnt lgkmcnt(6)
  v_mfma_f32_32x32x16_bf16 v[120:135], v[68:71], v[180:183], v[120:135]
  ds_read_b64_tr_b16 v[52:53], v27 offset:6144
  ds_read_b64_tr_b16 v[54:55], v27 offset:7168
  s_waitcnt vmcnt(15)
  s_waitcnt lgkmcnt(6)
  v_mfma_f32_32x32x16_bf16 v[72:87], v[40:43], v[184:187], v[72:87]
  ds_read_b64_tr_b16 v[56:57], v27 offset:16384
  ds_read_b64_tr_b16 v[58:59], v27 offset:17408
  buffer_load_dwordx4 v[240:243], v2, s[44:47], s93 offen offset:2048 sc1
  s_waitcnt vmcnt(15)
  s_waitcnt lgkmcnt(6)
  v_mfma_f32_32x32x16_bf16 v[72:87], v[44:47], v[188:191], v[72:87]
  ds_read_b64_tr_b16 v[60:61], v27 offset:18432
  ds_read_b64_tr_b16 v[62:63], v27 offset:19456
  s_waitcnt vmcnt(14)
  s_waitcnt lgkmcnt(6)
  v_mfma_f32_32x32x16_bf16 v[72:87], v[48:51], v[192:195], v[72:87]
  ds_read_b64_tr_b16 v[64:65], v27 offset:20480
  ds_read_b64_tr_b16 v[66:67], v27 offset:21504
  buffer_load_dwordx4 v[244:247], v2, s[44:47], s93 offen offset:3072 sc1
  s_waitcnt vmcnt(14)
  s_waitcnt lgkmcnt(6)
  v_mfma_f32_32x32x16_bf16 v[72:87], v[52:55], v[196:199], v[72:87]
  ds_read_b64_tr_b16 v[68:69], v27 offset:22528
  ds_read_b64_tr_b16 v[70:71], v27 offset:23552
  s_waitcnt vmcnt(13)
  s_waitcnt lgkmcnt(6)
  v_mfma_f32_32x32x16_bf16 v[72:87], v[56:59], v[200:203], v[72:87]
  ds_read_b64_tr_b16 v[40:41], v27 offset:32768
  ds_read_b64_tr_b16 v[42:43], v27 offset:33792
  s_waitcnt vmcnt(12)
  s_waitcnt lgkmcnt(6)
  v_mfma_f32_32x32x16_bf16 v[72:87], v[60:63], v[204:207], v[72:87]
  ds_read_b64_tr_b16 v[44:45], v27 offset:34816
  ds_read_b64_tr_b16 v[46:47], v27 offset:35840
  s_waitcnt vmcnt(11)
  s_waitcnt lgkmcnt(6)
  v_mfma_f32_32x32x16_bf16 v[72:87], v[64:67], v[208:211], v[72:87]
  ds_read_b64_tr_b16 v[48:49], v27 offset:36864
  ds_read_b64_tr_b16 v[50:51], v27 offset:37888
  s_waitcnt vmcnt(8)
  s_waitcnt lgkmcnt(6)
  v_mfma_f32_32x32x16_bf16 v[72:87], v[68:71], v[212:215], v[72:87]
  ds_read_b64_tr_b16 v[52:53], v27 offset:38912
  ds_read_b64_tr_b16 v[54:55], v27 offset:39936
  s_barrier
  s_waitcnt vmcnt(7)
  s_waitcnt lgkmcnt(6)
  v_mfma_f32_32x32x16_bf16 v[72:87], v[40:43], v[216:219], v[72:87]
  ds_read_b64_tr_b16 v[56:57], v27 offset:49152
  ds_read_b64_tr_b16 v[58:59], v27 offset:50176
  s_add_u32 m0, s85, 114688
  s_add_u32 s88, s95, 0
  buffer_load_dwordx4 v26, s[24:27], s88 offen lds
  s_waitcnt vmcnt(7)
  s_waitcnt lgkmcnt(6)
  v_mfma_f32_32x32x16_bf16 v[72:87], v[44:47], v[220:223], v[72:87]
  ds_read_b64_tr_b16 v[60:61], v27 offset:51200
  ds_read_b64_tr_b16 v[62:63], v27 offset:52224
  s_waitcnt vmcnt(6)
  s_waitcnt lgkmcnt(6)
  v_mfma_f32_32x32x16_bf16 v[72:87], v[48:51], v[224:227], v[72:87]
  ds_read_b64_tr_b16 v[64:65], v27 offset:53248
  ds_read_b64_tr_b16 v[66:67], v27 offset:54272
  s_add_u32 m0, s85, 122880
  s_add_u32 s88, s95, 14336
  buffer_load_dwordx4 v26, s[24:27], s88 offen lds
  s_waitcnt vmcnt(6)
  s_waitcnt lgkmcnt(6)
  v_mfma_f32_32x32x16_bf16 v[72:87], v[52:55], v[228:231], v[72:87]
  ds_read_b64_tr_b16 v[68:69], v27 offset:55296
  ds_read_b64_tr_b16 v[70:71], v27 offset:56320
  s_waitcnt vmcnt(5)
  s_waitcnt lgkmcnt(6)
  v_mfma_f32_32x32x16_bf16 v[72:87], v[56:59], v[232:235], v[72:87]
  v_add_u32 v28, 49152, v28
  ds_read_b64_tr_b16 v[40:41], v28 offset:0
  ds_read_b64_tr_b16 v[42:43], v28 offset:1024
  s_add_u32 m0, s85, 131072
  s_add_u32 s88, s95, 28672
  buffer_load_dwordx4 v26, s[24:27], s88 offen lds
  s_waitcnt vmcnt(5)
  s_waitcnt lgkmcnt(6)
  v_mfma_f32_32x32x16_bf16 v[72:87], v[60:63], v[236:239], v[72:87]
  ds_read_b64_tr_b16 v[44:45], v28 offset:2048
  ds_read_b64_tr_b16 v[46:47], v28 offset:3072
  s_waitcnt vmcnt(4)
  s_waitcnt lgkmcnt(6)
  v_mfma_f32_32x32x16_bf16 v[72:87], v[64:67], v[240:243], v[72:87]
  ds_read_b64_tr_b16 v[48:49], v28 offset:4096
  ds_read_b64_tr_b16 v[50:51], v28 offset:5120
  s_add_u32 m0, s85, 139264
  s_add_u32 s88, s95, 43008
  buffer_load_dwordx4 v26, s[24:27], s88 offen lds
  s_waitcnt vmcnt(4)
  s_waitcnt lgkmcnt(6)
  v_mfma_f32_32x32x16_bf16 v[72:87], v[68:71], v[244:247], v[72:87]
  ds_read_b64_tr_b16 v[52:53], v28 offset:6144
  ds_read_b64_tr_b16 v[54:55], v28 offset:7168
  s_waitcnt lgkmcnt(6)
  v_mfma_f32_32x32x16_bf16 v[88:103], v[40:43], v[184:187], v[88:103]
  ds_read_b64_tr_b16 v[56:57], v28 offset:16384
  ds_read_b64_tr_b16 v[58:59], v28 offset:17408
  s_add_u32 m0, s85, 147456
  s_add_u32 s88, s95, 57344
  buffer_load_dwordx4 v26, s[24:27], s88 offen lds
  s_waitcnt lgkmcnt(6)
  v_mfma_f32_32x32x16_bf16 v[88:103], v[44:47], v[188:191], v[88:103]
  ds_read_b64_tr_b16 v[60:61], v28 offset:18432
  ds_read_b64_tr_b16 v[62:63], v28 offset:19456
  v_mul_f32 v136, v72, v72
  v_mul_f32 v137, v73, v73
  v_mul_f32 v138, v74, v74
  v_mul_f32 v139, v75, v75
  v_mul_f32 v140, v76, v76
  s_waitcnt lgkmcnt(6)
  v_mfma_f32_32x32x16_bf16 v[88:103], v[48:51], v[192:195], v[88:103]
  ds_read_b64_tr_b16 v[64:65], v28 offset:20480
  ds_read_b64_tr_b16 v[66:67], v28 offset:21504
  s_add_u32 m0, s85, 155648
  s_add_u32 s88, s95, 71680
  buffer_load_dwordx4 v26, s[24:27], s88 offen lds
  v_mul_f32 v141, v77, v77
  v_mul_f32 v142, v78, v78
  v_mul_f32 v143, v79, v79
  v_fma_f32 v136, v136, v14, v12
  v_fma_f32 v137, v137, v14, v12
  s_waitcnt lgkmcnt(6)
  v_mfma_f32_32x32x16_bf16 v[88:103], v[52:55], v[196:199], v[88:103]
  ds_read_b64_tr_b16 v[68:69], v28 offset:22528
  ds_read_b64_tr_b16 v[70:71], v28 offset:23552
  v_fma_f32 v138, v138, v14, v12
  v_fma_f32 v139, v139, v14, v12
  v_fma_f32 v140, v140, v14, v12
  v_fma_f32 v141, v141, v14, v12
  v_fma_f32 v142, v142, v14, v12
  s_waitcnt lgkmcnt(6)
  v_mfma_f32_32x32x16_bf16 v[88:103], v[56:59], v[200:203], v[88:103]
  ds_read_b64_tr_b16 v[40:41], v28 offset:32768
  ds_read_b64_tr_b16 v[42:43], v28 offset:33792
  s_add_u32 m0, s85, 0
  s_add_u32 s88, s95, 86016
  buffer_load_dwordx4 v26, s[24:27], s88 offen lds
  v_fma_f32 v143, v143, v14, v12
  v_mul_f32 v136, v136, v72
  v_mul_f32 v137, v137, v73
  v_mul_f32 v138, v138, v74
  v_mul_f32 v139, v139, v75
  s_waitcnt lgkmcnt(6)
  v_mfma_f32_32x32x16_bf16 v[88:103], v[60:63], v[204:207], v[88:103]
  ds_read_b64_tr_b16 v[44:45], v28 offset:34816
  ds_read_b64_tr_b16 v[46:47], v28 offset:35840
  v_mul_f32 v140, v140, v76
  v_mul_f32 v141, v141, v77
  v_mul_f32 v142, v142, v78
  v_mul_f32 v143, v143, v79
  v_exp_f32 v136, v136
  s_waitcnt lgkmcnt(6)
  v_mfma_f32_32x32x16_bf16 v[88:103], v[64:67], v[208:211], v[88:103]
  ds_read_b64_tr_b16 v[48:49], v28 offset:36864
  ds_read_b64_tr_b16 v[50:51], v28 offset:37888
  s_add_u32 m0, s85, 8192
  s_add_u32 s88, s95, 100352
  buffer_load_dwordx4 v26, s[24:27], s88 offen lds
  v_mul_f32 v72, v72, v80
  v_exp_f32 v137, v137
  v_mul_f32 v73, v73, v81
  v_exp_f32 v138, v138
  s_waitcnt lgkmcnt(6)
  v_mfma_f32_32x32x16_bf16 v[88:103], v[68:71], v[212:215], v[88:103]
  ds_read_b64_tr_b16 v[52:53], v28 offset:38912
  ds_read_b64_tr_b16 v[54:55], v28 offset:39936
  v_mul_f32 v74, v74, v82
  v_exp_f32 v139, v139
  v_mul_f32 v75, v75, v83
  v_exp_f32 v140, v140
  s_waitcnt lgkmcnt(6)
  v_mfma_f32_32x32x16_bf16 v[88:103], v[40:43], v[216:219], v[88:103]
  ds_read_b64_tr_b16 v[56:57], v28 offset:49152
  ds_read_b64_tr_b16 v[58:59], v28 offset:50176
  s_add_u32 m0, s85, 16384
  s_add_u32 s88, s95, 114688
  buffer_load_dwordx4 v26, s[24:27], s88 offen lds
  v_mul_f32 v76, v76, v84
  v_exp_f32 v141, v141
  v_mul_f32 v77, v77, v85
  v_exp_f32 v142, v142
  s_waitcnt lgkmcnt(6)
  v_mfma_f32_32x32x16_bf16 v[88:103], v[44:47], v[220:223], v[88:103]
  ds_read_b64_tr_b16 v[60:61], v28 offset:51200
  ds_read_b64_tr_b16 v[62:63], v28 offset:52224
  v_mul_f32 v78, v78, v86
  v_exp_f32 v143, v143
  v_mul_f32 v79, v79, v87
  v_add_f32 v136, 1.0, v136
  s_waitcnt lgkmcnt(6)
  v_mfma_f32_32x32x16_bf16 v[88:103], v[48:51], v[224:227], v[88:103]
  ds_read_b64_tr_b16 v[64:65], v28 offset:53248
  ds_read_b64_tr_b16 v[66:67], v28 offset:54272
  s_add_u32 m0, s85, 24576
  s_add_u32 s88, s95, 129024
  buffer_load_dwordx4 v26, s[24:27], s88 offen lds
  v_add_f32 v137, 1.0, v137
  v_rcp_f32 v136, v136
  v_add_f32 v138, 1.0, v138
  v_rcp_f32 v137, v137
  s_waitcnt lgkmcnt(6)
  v_mfma_f32_32x32x16_bf16 v[88:103], v[52:55], v[228:231], v[88:103]
  ds_read_b64_tr_b16 v[68:69], v28 offset:55296
  ds_read_b64_tr_b16 v[70:71], v28 offset:56320
  v_add_f32 v139, 1.0, v139
  v_rcp_f32 v138, v138
  v_add_f32 v140, 1.0, v140
  v_rcp_f32 v139, v139
  s_waitcnt lgkmcnt(6)
  v_mfma_f32_32x32x16_bf16 v[88:103], v[56:59], v[232:235], v[88:103]
  v_add_u32 v29, 49152, v29
  ds_read_b64_tr_b16 v[40:41], v29 offset:0
  ds_read_b64_tr_b16 v[42:43], v29 offset:1024
  s_add_u32 m0, s85, 32768
  s_add_u32 s88, s95, 143360
  buffer_load_dwordx4 v26, s[24:27], s88 offen lds
  v_add_f32 v141, 1.0, v141
  v_rcp_f32 v140, v140
  v_add_f32 v142, 1.0, v142
  v_rcp_f32 v141, v141
  s_waitcnt lgkmcnt(6)
  v_mfma_f32_32x32x16_bf16 v[88:103], v[60:63], v[236:239], v[88:103]
  ds_read_b64_tr_b16 v[44:45], v29 offset:2048
  ds_read_b64_tr_b16 v[46:47], v29 offset:3072
  v_add_f32 v143, 1.0, v143
  v_rcp_f32 v142, v142
  v_rcp_f32 v143, v143
  s_waitcnt lgkmcnt(6)
  v_mfma_f32_32x32x16_bf16 v[88:103], v[64:67], v[240:243], v[88:103]
  ds_read_b64_tr_b16 v[48:49], v29 offset:4096
  ds_read_b64_tr_b16 v[50:51], v29 offset:5120
  s_add_u32 m0, s85, 40960
  s_add_u32 s88, s95, 157696
  buffer_load_dwordx4 v26, s[24:27], s88 offen lds
  v_mul_f32 v72, v72, v136
  v_mul_f32 v73, v73, v137
  v_mul_f32 v74, v74, v138
  v_mul_f32 v75, v75, v139
  v_mul_f32 v76, v76, v140
  s_waitcnt lgkmcnt(6)
  v_mfma_f32_32x32x16_bf16 v[88:103], v[68:71], v[244:247], v[88:103]
  ds_read_b64_tr_b16 v[52:53], v29 offset:6144
  ds_read_b64_tr_b16 v[54:55], v29 offset:7168
  v_mul_f32 v77, v77, v141
  v_mul_f32 v78, v78, v142
  v_mul_f32 v79, v79, v143
  v_cvt_pk_bf16_f32 v168, v72, v73
  v_cvt_pk_bf16_f32 v169, v74, v75
  s_waitcnt lgkmcnt(6)
  v_mfma_f32_32x32x16_bf16 v[104:119], v[40:43], v[184:187], v[104:119]
  ds_read_b64_tr_b16 v[56:57], v29 offset:16384
  ds_read_b64_tr_b16 v[58:59], v29 offset:17408
  v_cvt_pk_bf16_f32 v170, v76, v77
  v_cvt_pk_bf16_f32 v171, v78, v79
  buffer_store_dwordx4 v[168:171], v2, s[44:47], s96 offen offset:0 sc1
  s_waitcnt lgkmcnt(6)
  v_mfma_f32_32x32x16_bf16 v[104:119], v[44:47], v[188:191], v[104:119]
  ds_read_b64_tr_b16 v[60:61], v29 offset:18432
  ds_read_b64_tr_b16 v[62:63], v29 offset:19456
  v_mul_f32 v152, v88, v88
  v_mul_f32 v153, v89, v89
  v_mul_f32 v154, v90, v90
  v_mul_f32 v155, v91, v91
  v_mul_f32 v156, v92, v92
  s_waitcnt lgkmcnt(6)
  v_mfma_f32_32x32x16_bf16 v[104:119], v[48:51], v[192:195], v[104:119]
  ds_read_b64_tr_b16 v[64:65], v29 offset:20480
  ds_read_b64_tr_b16 v[66:67], v29 offset:21504
  v_mul_f32 v157, v93, v93
  v_mul_f32 v158, v94, v94
  v_mul_f32 v159, v95, v95
  v_fma_f32 v152, v152, v14, v12
  v_fma_f32 v153, v153, v14, v12
  s_waitcnt lgkmcnt(6)
  v_mfma_f32_32x32x16_bf16 v[104:119], v[52:55], v[196:199], v[104:119]
  ds_read_b64_tr_b16 v[68:69], v29 offset:22528
  ds_read_b64_tr_b16 v[70:71], v29 offset:23552
  v_fma_f32 v154, v154, v14, v12
  v_fma_f32 v155, v155, v14, v12
  v_fma_f32 v156, v156, v14, v12
  v_fma_f32 v157, v157, v14, v12
  v_fma_f32 v158, v158, v14, v12
  s_waitcnt lgkmcnt(6)
  v_mfma_f32_32x32x16_bf16 v[104:119], v[56:59], v[200:203], v[104:119]
  ds_read_b64_tr_b16 v[40:41], v29 offset:32768
  ds_read_b64_tr_b16 v[42:43], v29 offset:33792
  v_fma_f32 v159, v159, v14, v12
  v_mul_f32 v152, v152, v88
  v_mul_f32 v153, v153, v89
  v_mul_f32 v154, v154, v90
  v_mul_f32 v155, v155, v91
  s_waitcnt lgkmcnt(6)
  v_mfma_f32_32x32x16_bf16 v[104:119], v[60:63], v[204:207], v[104:119]
  ds_read_b64_tr_b16 v[44:45], v29 offset:34816
  ds_read_b64_tr_b16 v[46:47], v29 offset:35840
  v_mul_f32 v156, v156, v92
  v_mul_f32 v157, v157, v93
  v_mul_f32 v158, v158, v94
  v_mul_f32 v159, v159, v95
  v_exp_f32 v152, v152
  s_waitcnt lgkmcnt(6)
  v_mfma_f32_32x32x16_bf16 v[104:119], v[64:67], v[208:211], v[104:119]
  ds_read_b64_tr_b16 v[48:49], v29 offset:36864
  ds_read_b64_tr_b16 v[50:51], v29 offset:37888
  v_mul_f32 v88, v88, v96
  v_exp_f32 v153, v153
  v_mul_f32 v89, v89, v97
  v_exp_f32 v154, v154
  s_waitcnt lgkmcnt(6)
  v_mfma_f32_32x32x16_bf16 v[104:119], v[68:71], v[212:215], v[104:119]
  ds_read_b64_tr_b16 v[52:53], v29 offset:38912
  ds_read_b64_tr_b16 v[54:55], v29 offset:39936
  v_mul_f32 v90, v90, v98
  v_exp_f32 v155, v155
  v_mul_f32 v91, v91, v99
  v_exp_f32 v156, v156
  s_waitcnt lgkmcnt(6)
  v_mfma_f32_32x32x16_bf16 v[104:119], v[40:43], v[216:219], v[104:119]
  ds_read_b64_tr_b16 v[56:57], v29 offset:49152
  ds_read_b64_tr_b16 v[58:59], v29 offset:50176
  v_mul_f32 v92, v92, v100
  v_exp_f32 v157, v157
  v_mul_f32 v93, v93, v101
  v_exp_f32 v158, v158
  s_waitcnt lgkmcnt(6)
  v_mfma_f32_32x32x16_bf16 v[104:119], v[44:47], v[220:223], v[104:119]
  ds_read_b64_tr_b16 v[60:61], v29 offset:51200
  ds_read_b64_tr_b16 v[62:63], v29 offset:52224
  v_mul_f32 v94, v94, v102
  v_exp_f32 v159, v159
  v_mul_f32 v95, v95, v103
  v_add_f32 v152, 1.0, v152
  s_waitcnt lgkmcnt(6)
  v_mfma_f32_32x32x16_bf16 v[104:119], v[48:51], v[224:227], v[104:119]
  ds_read_b64_tr_b16 v[64:65], v29 offset:53248
  ds_read_b64_tr_b16 v[66:67], v29 offset:54272
  v_add_f32 v153, 1.0, v153
  v_rcp_f32 v152, v152
  v_add_f32 v154, 1.0, v154
  v_rcp_f32 v153, v153
  s_waitcnt lgkmcnt(6)
  v_mfma_f32_32x32x16_bf16 v[104:119], v[52:55], v[228:231], v[104:119]
  ds_read_b64_tr_b16 v[68:69], v29 offset:55296
  ds_read_b64_tr_b16 v[70:71], v29 offset:56320
  v_add_f32 v155, 1.0, v155
  v_rcp_f32 v154, v154
  v_add_f32 v156, 1.0, v156
  v_rcp_f32 v155, v155
  s_waitcnt lgkmcnt(6)
  v_mfma_f32_32x32x16_bf16 v[104:119], v[56:59], v[232:235], v[104:119]
  v_add_u32 v30, 49152, v30
  ds_read_b64_tr_b16 v[40:41], v30 offset:0
  ds_read_b64_tr_b16 v[42:43], v30 offset:1024
  v_add_f32 v157, 1.0, v157
  v_rcp_f32 v156, v156
  v_add_f32 v158, 1.0, v158
  v_rcp_f32 v157, v157
  s_waitcnt lgkmcnt(6)
  v_mfma_f32_32x32x16_bf16 v[104:119], v[60:63], v[236:239], v[104:119]
  ds_read_b64_tr_b16 v[44:45], v30 offset:2048
  ds_read_b64_tr_b16 v[46:47], v30 offset:3072
  v_add_f32 v159, 1.0, v159
  v_rcp_f32 v158, v158
  v_rcp_f32 v159, v159
  s_waitcnt lgkmcnt(6)
  v_mfma_f32_32x32x16_bf16 v[104:119], v[64:67], v[240:243], v[104:119]
  ds_read_b64_tr_b16 v[48:49], v30 offset:4096
  ds_read_b64_tr_b16 v[50:51], v30 offset:5120
  v_mul_f32 v88, v88, v152
  v_mul_f32 v89, v89, v153
  v_mul_f32 v90, v90, v154
  v_mul_f32 v91, v91, v155
  v_mul_f32 v92, v92, v156
  s_waitcnt lgkmcnt(6)
  v_mfma_f32_32x32x16_bf16 v[104:119], v[68:71], v[244:247], v[104:119]
  ds_read_b64_tr_b16 v[52:53], v30 offset:6144
  ds_read_b64_tr_b16 v[54:55], v30 offset:7168
  v_mul_f32 v93, v93, v157
  v_mul_f32 v94, v94, v158
  v_mul_f32 v95, v95, v159
  v_cvt_pk_bf16_f32 v172, v88, v89
  v_cvt_pk_bf16_f32 v173, v90, v91
  s_waitcnt lgkmcnt(6)
  v_mfma_f32_32x32x16_bf16 v[120:135], v[40:43], v[184:187], v[120:135]
  ds_read_b64_tr_b16 v[56:57], v30 offset:16384
  ds_read_b64_tr_b16 v[58:59], v30 offset:17408
  v_cvt_pk_bf16_f32 v174, v92, v93
  v_cvt_pk_bf16_f32 v175, v94, v95
  s_mov_b64 exec, 0xff
  buffer_load_dword v255, v17, s[44:47], s96 offen offset:0 sc1
  s_mov_b64 exec, -1
  buffer_store_dwordx4 v[172:175], v2, s[44:47], s96 offen offset:1024 sc1
  s_waitcnt lgkmcnt(6)
  v_mfma_f32_32x32x16_bf16 v[120:135], v[44:47], v[188:191], v[120:135]
  ds_read_b64_tr_b16 v[60:61], v30 offset:18432
  ds_read_b64_tr_b16 v[62:63], v30 offset:19456
  v_mul_f32 v136, v104, v104
  v_mul_f32 v137, v105, v105
  v_mul_f32 v138, v106, v106
  v_mul_f32 v139, v107, v107
  v_mul_f32 v140, v108, v108
  s_waitcnt lgkmcnt(6)
  v_mfma_f32_32x32x16_bf16 v[120:135], v[48:51], v[192:195], v[120:135]
  ds_read_b64_tr_b16 v[64:65], v30 offset:20480
  ds_read_b64_tr_b16 v[66:67], v30 offset:21504
  v_mul_f32 v141, v109, v109
  v_mul_f32 v142, v110, v110
  v_mul_f32 v143, v111, v111
  v_fma_f32 v136, v136, v14, v12
  v_fma_f32 v137, v137, v14, v12
  s_waitcnt lgkmcnt(6)
  v_mfma_f32_32x32x16_bf16 v[120:135], v[52:55], v[196:199], v[120:135]
  ds_read_b64_tr_b16 v[68:69], v30 offset:22528
  ds_read_b64_tr_b16 v[70:71], v30 offset:23552
  v_fma_f32 v138, v138, v14, v12
  v_fma_f32 v139, v139, v14, v12
  v_fma_f32 v140, v140, v14, v12
  v_fma_f32 v141, v141, v14, v12
  v_fma_f32 v142, v142, v14, v12
  s_waitcnt lgkmcnt(6)
  v_mfma_f32_32x32x16_bf16 v[120:135], v[56:59], v[200:203], v[120:135]
  ds_read_b64_tr_b16 v[40:41], v30 offset:32768
  ds_read_b64_tr_b16 v[42:43], v30 offset:33792
  v_fma_f32 v143, v143, v14, v12
  v_mul_f32 v136, v136, v104
  v_mul_f32 v137, v137, v105
  v_mul_f32 v138, v138, v106
  v_mul_f32 v139, v139, v107
  s_waitcnt lgkmcnt(6)
  v_mfma_f32_32x32x16_bf16 v[120:135], v[60:63], v[204:207], v[120:135]
  ds_read_b64_tr_b16 v[44:45], v30 offset:34816
  ds_read_b64_tr_b16 v[46:47], v30 offset:35840
  v_mul_f32 v140, v140, v108
  v_mul_f32 v141, v141, v109
  v_mul_f32 v142, v142, v110
  v_mul_f32 v143, v143, v111
  v_exp_f32 v136, v136
  s_waitcnt lgkmcnt(6)
  v_mfma_f32_32x32x16_bf16 v[120:135], v[64:67], v[208:211], v[120:135]
  ds_read_b64_tr_b16 v[48:49], v30 offset:36864
  ds_read_b64_tr_b16 v[50:51], v30 offset:37888
  v_mul_f32 v104, v104, v112
  v_exp_f32 v137, v137
  v_mul_f32 v105, v105, v113
  v_exp_f32 v138, v138
  s_waitcnt lgkmcnt(6)
  v_mfma_f32_32x32x16_bf16 v[120:135], v[68:71], v[212:215], v[120:135]
  ds_read_b64_tr_b16 v[52:53], v30 offset:38912
  ds_read_b64_tr_b16 v[54:55], v30 offset:39936
  v_mul_f32 v106, v106, v114
  v_exp_f32 v139, v139
  v_mul_f32 v107, v107, v115
  v_exp_f32 v140, v140
  s_waitcnt lgkmcnt(6)
  v_mfma_f32_32x32x16_bf16 v[120:135], v[40:43], v[216:219], v[120:135]
  ds_read_b64_tr_b16 v[56:57], v30 offset:49152
  ds_read_b64_tr_b16 v[58:59], v30 offset:50176
  v_mul_f32 v108, v108, v116
  v_exp_f32 v141, v141
  v_mul_f32 v109, v109, v117
  v_exp_f32 v142, v142
  s_waitcnt lgkmcnt(6)
  v_mfma_f32_32x32x16_bf16 v[120:135], v[44:47], v[220:223], v[120:135]
  ds_read_b64_tr_b16 v[60:61], v30 offset:51200
  ds_read_b64_tr_b16 v[62:63], v30 offset:52224
  v_mul_f32 v110, v110, v118
  v_exp_f32 v143, v143
  v_mul_f32 v111, v111, v119
  v_add_f32 v136, 1.0, v136
  s_waitcnt lgkmcnt(6)
  v_mfma_f32_32x32x16_bf16 v[120:135], v[48:51], v[224:227], v[120:135]
  ds_read_b64_tr_b16 v[64:65], v30 offset:53248
  ds_read_b64_tr_b16 v[66:67], v30 offset:54272
  v_add_f32 v137, 1.0, v137
  v_rcp_f32 v136, v136
  v_add_f32 v138, 1.0, v138
  v_rcp_f32 v137, v137
  s_waitcnt lgkmcnt(6)
  v_mfma_f32_32x32x16_bf16 v[120:135], v[52:55], v[228:231], v[120:135]
  ds_read_b64_tr_b16 v[68:69], v30 offset:55296
  ds_read_b64_tr_b16 v[70:71], v30 offset:56320
  v_add_f32 v139, 1.0, v139
  v_rcp_f32 v138, v138
  v_add_f32 v140, 1.0, v140
  v_rcp_f32 v139, v139
  s_waitcnt lgkmcnt(6)
  v_mfma_f32_32x32x16_bf16 v[120:135], v[56:59], v[232:235], v[120:135]
  v_add_f32 v141, 1.0, v141
  v_rcp_f32 v140, v140
  v_add_f32 v142, 1.0, v142
  v_rcp_f32 v141, v141
  s_waitcnt lgkmcnt(4)
  v_mfma_f32_32x32x16_bf16 v[120:135], v[60:63], v[236:239], v[120:135]
  v_add_f32 v143, 1.0, v143
  v_rcp_f32 v142, v142
  v_rcp_f32 v143, v143
  s_waitcnt lgkmcnt(2)
  v_mfma_f32_32x32x16_bf16 v[120:135], v[64:67], v[240:243], v[120:135]
  v_mul_f32 v104, v104, v136
  v_mul_f32 v105, v105, v137
  v_mul_f32 v106, v106, v138
  v_mul_f32 v107, v107, v139
  v_mul_f32 v108, v108, v140
  s_waitcnt lgkmcnt(0)
  v_mfma_f32_32x32x16_bf16 v[120:135], v[68:71], v[244:247], v[120:135]
  v_mul_f32 v109, v109, v141
  v_mul_f32 v110, v110, v142
  v_mul_f32 v111, v111, v143
  v_cvt_pk_bf16_f32 v176, v104, v105
  v_cvt_pk_bf16_f32 v177, v106, v107
  v_cvt_pk_bf16_f32 v178, v108, v109
  v_cvt_pk_bf16_f32 v179, v110, v111
  s_mov_b64 exec, 0xff
  buffer_load_dword v255, v17, s[44:47], s96 offen offset:1024 sc1
  s_mov_b64 exec, -1
  buffer_store_dwordx4 v[176:179], v2, s[44:47], s96 offen offset:2048 sc1
  s_mov_b32 s98, 1.0
  s_mov_b32 s99, 1.0
  v_pk_mul_f32 v[152:153], v[120:121], v[120:121]
  v_pk_mul_f32 v[154:155], v[122:123], v[122:123]
  v_pk_mul_f32 v[156:157], v[124:125], v[124:125]
  v_pk_mul_f32 v[158:159], v[126:127], v[126:127]
  v_pk_fma_f32 v[152:153], v[152:153], v[14:15], v[12:13]
  v_pk_fma_f32 v[154:155], v[154:155], v[14:15], v[12:13]
  v_pk_fma_f32 v[156:157], v[156:157], v[14:15], v[12:13]
  v_pk_fma_f32 v[158:159], v[158:159], v[14:15], v[12:13]
  v_pk_mul_f32 v[152:153], v[152:153], v[120:121]
  v_pk_mul_f32 v[154:155], v[154:155], v[122:123]
  v_pk_mul_f32 v[156:157], v[156:157], v[124:125]
  v_pk_mul_f32 v[158:159], v[158:159], v[126:127]
  v_exp_f32 v152, v152
  v_exp_f32 v153, v153
  v_exp_f32 v154, v154
  v_exp_f32 v155, v155
  v_exp_f32 v156, v156
  v_exp_f32 v157, v157
  v_exp_f32 v158, v158
  v_exp_f32 v159, v159
  v_pk_mul_f32 v[120:121], v[120:121], v[128:129]
  v_pk_mul_f32 v[122:123], v[122:123], v[130:131]
  v_pk_mul_f32 v[124:125], v[124:125], v[132:133]
  v_pk_mul_f32 v[126:127], v[126:127], v[134:135]
  v_pk_add_f32 v[152:153], v[152:153], s[98:99]
  v_pk_add_f32 v[154:155], v[154:155], s[98:99]
  v_pk_add_f32 v[156:157], v[156:157], s[98:99]
  v_pk_add_f32 v[158:159], v[158:159], s[98:99]
  v_rcp_f32 v152, v152
  v_rcp_f32 v153, v153
  v_rcp_f32 v154, v154
  v_rcp_f32 v155, v155
  v_rcp_f32 v156, v156
  v_rcp_f32 v157, v157
  v_rcp_f32 v158, v158
  v_rcp_f32 v159, v159
  v_pk_mul_f32 v[120:121], v[120:121], v[152:153]
  v_pk_mul_f32 v[122:123], v[122:123], v[154:155]
  v_pk_mul_f32 v[124:125], v[124:125], v[156:157]
  v_pk_mul_f32 v[126:127], v[126:127], v[158:159]
  v_cvt_pk_bf16_f32 v180, v120, v121
  v_cvt_pk_bf16_f32 v181, v122, v123
  v_cvt_pk_bf16_f32 v182, v124, v125
  v_cvt_pk_bf16_f32 v183, v126, v127
  buffer_store_dwordx4 v[180:183], v2, s[44:47], s96 offen offset:3072 sc1
  s_cmp_lg_u32 s55, 0
  s_cbranch_scc1 adaLN_cond__sliding_local_dilated__glu_gated_geglu__prompt_kernel_m55
  s_waitcnt vmcnt(0)
  s_mov_b64 exec, 1
  buffer_store_dword v4, off, s[44:47], s94
  s_mov_b64 exec, -1
adaLN_cond__sliding_local_dilated__glu_gated_geglu__prompt_kernel_e56:
  s_mov_b64 exec, 0xffff
  buffer_load_dword v255, v17, s[44:47], s96 offen offset:2048 sc1
  s_mov_b64 exec, -1
  s_lshl_b32 s89, s62, 7
  s_mul_i32 s88, s63, 28
  s_add_u32 s89, s89, s88
  s_add_u32 s89, s89, s56
  s_add_u32 s89, s89, 3072
  s_mul_i32 s93, s92, 114688
  s_mul_i32 s88, s63, 28672
  s_add_u32 s93, s93, s88
  s_add_u32 s93, s93, 6160384
  s_barrier
  s_add_u32 m0, s85, 49152
  s_add_u32 s88, s95, 172032
  buffer_load_dwordx4 v26, s[24:27], s88 offen lds
  s_add_u32 m0, s85, 57344
  s_add_u32 s88, s95, 186368
  buffer_load_dwordx4 v26, s[24:27], s88 offen lds
  s_add_u32 m0, s85, 65536
  s_add_u32 s88, s95, 200704
  buffer_load_dwordx4 v26, s[24:27], s88 offen lds
  s_add_u32 m0, s85, 73728
  s_add_u32 s88, s95, 215040
  buffer_load_dwordx4 v26, s[24:27], s88 offen lds
  s_add_u32 m0, s85, 81920
  s_add_u32 s88, s95, 229376
  buffer_load_dwordx4 v26, s[24:27], s88 offen lds
  s_add_u32 m0, s85, 90112
  s_add_u32 s88, s95, 243712
  buffer_load_dwordx4 v26, s[24:27], s88 offen lds
  s_add_u32 m0, s85, 98304
  s_add_u32 s88, s95, 258048
  buffer_load_dwordx4 v26, s[24:27], s88 offen lds
  s_add_u32 m0, s85, 106496
  s_add_u32 s88, s95, 272384
  buffer_load_dwordx4 v26, s[24:27], s88 offen lds
  ds_read_b64_tr_b16 v[40:41], v33 offset:0
  ds_read_b64_tr_b16 v[42:43], v33 offset:1024
  ds_read_b64_tr_b16 v[44:45], v36 offset:0
  ds_read_b64_tr_b16 v[46:47], v36 offset:1024
  ds_read_b64_tr_b16 v[48:49], v33 offset:8192
  ds_read_b64_tr_b16 v[50:51], v33 offset:9216
  ds_read_b64_tr_b16 v[52:53], v36 offset:8192
  ds_read_b64_tr_b16 v[54:55], v36 offset:9216
  s_lshl_b32 s88, s62, 7
  s_lshl_b32 s90, s60, 2
  s_add_u32 s88, s88, s90
  s_add_u32 s88, s88, s56
  s_add_u32 s88, s88, 2080
  v_min_u32 v3, 6, v1
  v_lshlrev_b32 v3, 2, v3
  s_mov_b32 s99, 262144
  v_add_u32 v3, s89, v3
  v_writelane_b32 v3, s88, 63
adaLN_cond__sliding_local_dilated__glu_gated_geglu__prompt_kernel_p57:
  buffer_load_dword v8, v3, s[44:47], 0 offen sc1
  s_waitcnt vmcnt(0)
  v_cmp_ne_u32 vcc, 1, v8
  s_sub_u32 s99, s99, 1
  s_cbranch_scc1 adaLN_cond__sliding_local_dilated__glu_gated_geglu__prompt_kernel_d58
  s_cbranch_vccnz adaLN_cond__sliding_local_dilated__glu_gated_geglu__prompt_kernel_p57
adaLN_cond__sliding_local_dilated__glu_gated_geglu__prompt_kernel_d58:
  buffer_load_dwordx4 v[136:139], v2, s[44:47], s93 offen offset:0 sc1
  buffer_load_dwordx4 v[140:143], v2, s[44:47], s93 offen offset:1024 sc1
  buffer_load_dwordx4 v[144:147], v2, s[44:47], s93 offen offset:2048 sc1
  buffer_load_dwordx4 v[148:151], v2, s[44:47], s93 offen offset:3072 sc1
  s_add_u32 s93, s93, 4096
  buffer_load_dwordx4 v[152:155], v2, s[44:47], s93 offen offset:0 sc1
  buffer_load_dwordx4 v[156:159], v2, s[44:47], s93 offen offset:1024 sc1
  s_waitcnt vmcnt(5)
  s_waitcnt lgkmcnt(6)
  v_mfma_f32_32x32x16_bf16 v[72:87], v[40:43], v[136:139], 0
  ds_read_b64_tr_b16 v[56:57], v33 offset:16384
  ds_read_b64_tr_b16 v[58:59], v33 offset:17408
  buffer_load_dwordx4 v[160:163], v2, s[44:47], s93 offen offset:2048 sc1
  s_waitcnt lgkmcnt(6)
  v_mfma_f32_32x32x16_bf16 v[88:103], v[44:47], v[136:139], 0
  ds_read_b64_tr_b16 v[60:61], v36 offset:16384
  ds_read_b64_tr_b16 v[62:63], v36 offset:17408
  s_waitcnt vmcnt(5)
  s_waitcnt lgkmcnt(6)
  v_mfma_f32_32x32x16_bf16 v[72:87], v[48:51], v[140:143], v[72:87]
  ds_read_b64_tr_b16 v[64:65], v33 offset:24576
  ds_read_b64_tr_b16 v[66:67], v33 offset:25600
  buffer_load_dwordx4 v[164:167], v2, s[44:47], s93 offen offset:3072 sc1
  s_waitcnt lgkmcnt(6)
  v_mfma_f32_32x32x16_bf16 v[88:103], v[52:55], v[140:143], v[88:103]
  ds_read_b64_tr_b16 v[68:69], v36 offset:24576
  ds_read_b64_tr_b16 v[70:71], v36 offset:25600
  s_barrier
  s_waitcnt vmcnt(5)
  s_waitcnt lgkmcnt(6)
  v_mfma_f32_32x32x16_bf16 v[72:87], v[56:59], v[144:147], v[72:87]
  ds_read_b64_tr_b16 v[40:41], v33 offset:32768
  ds_read_b64_tr_b16 v[42:43], v33 offset:33792
  s_add_u32 s93, s93, 4096
  buffer_load_dwordx4 v[168:171], v2, s[44:47], s93 offen offset:0 sc1
  s_waitcnt lgkmcnt(6)
  v_mfma_f32_32x32x16_bf16 v[88:103], v[60:63], v[144:147], v[88:103]
  ds_read_b64_tr_b16 v[44:45], v36 offset:32768
  ds_read_b64_tr_b16 v[46:47], v36 offset:33792
  s_add_u32 m0, s85, 114688
  s_add_u32 s88, s95, 286720
  buffer_load_dwordx4 v26, s[24:27], s88 offen lds
  s_waitcnt vmcnt(6)
  s_waitcnt lgkmcnt(6)
  v_mfma_f32_32x32x16_bf16 v[72:87], v[64:67], v[148:151], v[72:87]
  ds_read_b64_tr_b16 v[48:49], v33 offset:40960
  ds_read_b64_tr_b16 v[50:51], v33 offset:41984
  buffer_load_dwordx4 v[172:175], v2, s[44:47], s93 offen offset:1024 sc1
  s_waitcnt lgkmcnt(6)
  v_mfma_f32_32x32x16_bf16 v[88:103], v[68:71], v[148:151], v[88:103]
  ds_read_b64_tr_b16 v[52:53], v36 offset:40960
  ds_read_b64_tr_b16 v[54:55], v36 offset:41984
  s_add_u32 m0, s85, 122880
  s_add_u32 s88, s95, 301056
  buffer_load_dwordx4 v26, s[24:27], s88 offen lds
  s_waitcnt vmcnt(7)
  s_waitcnt lgkmcnt(6)
  v_mfma_f32_32x32x16_bf16 v[72:87], v[40:43], v[152:155], v[72:87]
  ds_read_b64_tr_b16 v[56:57], v31 offset:0
  ds_read_b64_tr_b16 v[58:59], v31 offset:1024
  buffer_load_dwordx4 v[176:179], v2, s[44:47], s93 offen offset:2048 sc1
  s_waitcnt lgkmcnt(6)
  v_mfma_f32_32x32x16_bf16 v[88:103], v[44:47], v[152:155], v[88:103]
  ds_read_b64_tr_b16 v[60:61], v34 offset:0
  ds_read_b64_tr_b16 v[62:63], v34 offset:1024
  s_waitcnt vmcnt(7)
  s_waitcnt lgkmcnt(6)
  v_mfma_f32_32x32x16_bf16 v[72:87], v[48:51], v[156:159], v[72:87]
  ds_read_b64_tr_b16 v[64:65], v31 offset:8192
  ds_read_b64_tr_b16 v[66:67], v31 offset:9216
  buffer_load_dwordx4 v[180:183], v2, s[44:47], s93 offen offset:3072 sc1
  s_waitcnt lgkmcnt(6)
  v_mfma_f32_32x32x16_bf16 v[88:103], v[52:55], v[156:159], v[88:103]
  ds_read_b64_tr_b16 v[68:69], v34 offset:8192
  ds_read_b64_tr_b16 v[70:71], v34 offset:9216
  s_barrier
  s_waitcnt vmcnt(7)
  s_waitcnt lgkmcnt(6)
  v_mfma_f32_32x32x16_bf16 v[72:87], v[56:59], v[160:163], v[72:87]
  ds_read_b64_tr_b16 v[40:41], v31 offset:16384
  ds_read_b64_tr_b16 v[42:43], v31 offset:17408
  s_add_u32 s93, s93, 4096
  buffer_load_dwordx4 v[184:187], v2, s[44:47], s93 offen offset:0 sc1
  s_waitcnt lgkmcnt(6)
  v_mfma_f32_32x32x16_bf16 v[88:103], v[60:63], v[160:163], v[88:103]
  ds_read_b64_tr_b16 v[44:45], v34 offset:16384
  ds_read_b64_tr_b16 v[46:47], v34 offset:17408
  s_add_u32 m0, s85, 131072
  s_add_u32 s88, s95, 315392
  buffer_load_dwordx4 v26, s[24:27], s88 offen lds
  s_waitcnt vmcnt(8)
  s_waitcnt lgkmcnt(6)
  v_mfma_f32_32x32x16_bf16 v[72:87], v[64:67], v[164:167], v[72:87]
  ds_read_b64_tr_b16 v[48:49], v31 offset:24576
  ds_read_b64_tr_b16 v[50:51], v31 offset:25600
  buffer_load_dwordx4 v[188:191], v2, s[44:47], s93 offen offset:1024 sc1
  s_waitcnt lgkmcnt(6)
  v_mfma_f32_32x32x16_bf16 v[88:103], v[68:71], v[164:167], v[88:103]
  ds_read_b64_tr_b16 v[52:53], v34 offset:24576
  ds_read_b64_tr_b16 v[54:55], v34 offset:25600
  s_add_u32 m0, s85, 139264
  s_add_u32 s88, s95, 329728
  buffer_load_dwordx4 v26, s[24:27], s88 offen lds
  s_waitcnt vmcnt(9)
  s_waitcnt lgkmcnt(6)
  v_mfma_f32_32x32x16_bf16 v[72:87], v[40:43], v[168:171], v[72:87]
  ds_read_b64_tr_b16 v[56:57], v31 offset:32768
  ds_read_b64_tr_b16 v[58:59], v31 offset:33792
  buffer_load_dwordx4 v[192:195], v2, s[44:47], s93 offen offset:2048 sc1
  s_waitcnt lgkmcnt(6)
  v_mfma_f32_32x32x16_bf16 v[88:103], v[44:47], v[168:171], v[88:103]
  ds_read_b64_tr_b16 v[60:61], v34 offset:32768
  ds_read_b64_tr_b16 v[62:63], v34 offset:33792
  s_add_u32 m0, s85, 147456
  s_add_u32 s88, s95, 344064
  buffer_load_dwordx4 v26, s[24:27], s88 offen lds
  s_waitcnt vmcnt(9)
  s_waitcnt lgkmcnt(6)
  v_mfma_f32_32x32x16_bf16 v[72:87], v[48:51], v[172:175], v[72:87]
  ds_read_b64_tr_b16 v[64:65], v31 offset:40960
  ds_read_b64_tr_b16 v[66:67], v31 offset:41984
  buffer_load_dwordx4 v[196:199], v2, s[44:47], s93 offen offset:3072 sc1
  s_waitcnt lgkmcnt(6)
  v_mfma_f32_32x32x16_bf16 v[88:103], v[52:55], v[172:175], v[88:103]
  ds_read_b64_tr_b16 v[68:69], v34 offset:40960
  ds_read_b64_tr_b16 v[70:71], v34 offset:41984
  s_add_u32 m0, s85, 155648
  s_add_u32 s88, s95, 358400
  buffer_load_dwordx4 v26, s[24:27], s88 offen lds
  s_barrier
  s_waitcnt vmcnt(9)
  s_waitcnt lgkmcnt(6)
  v_mfma_f32_32x32x16_bf16 v[72:87], v[56:59], v[176:179], v[72:87]
  ds_read_b64_tr_b16 v[40:41], v31 offset:49152
  ds_read_b64_tr_b16 v[42:43], v31 offset:50176
  s_add_u32 s93, s93, 4096
  buffer_load_dwordx4 v[200:203], v2, s[44:47], s93 offen offset:0 sc1
  s_waitcnt lgkmcnt(6)
  v_mfma_f32_32x32x16_bf16 v[88:103], v[60:63], v[176:179], v[88:103]
  ds_read_b64_tr_b16 v[44:45], v34 offset:49152
  ds_read_b64_tr_b16 v[46:47], v34 offset:50176
  s_add_u32 m0, s85, 0
  s_add_u32 s88, s95, 372736
  buffer_load_dwordx4 v26, s[24:27], s88 offen lds
  s_waitcnt vmcnt(10)
  s_waitcnt lgkmcnt(6)
  v_mfma_f32_32x32x16_bf16 v[72:87], v[64:67], v[180:183], v[72:87]
  ds_read_b64_tr_b16 v[48:49], v32 offset:0
  ds_read_b64_tr_b16 v[50:51], v32 offset:1024
  buffer_load_dwordx4 v[204:207], v2, s[44:47], s93 offen offset:1024 sc1
  s_waitcnt lgkmcnt(6)
  v_mfma_f32_32x32x16_bf16 v[88:103], v[68:71], v[180:183], v[88:103]
  ds_read_b64_tr_b16 v[52:53], v35 offset:0
  ds_read_b64_tr_b16 v[54:55], v35 offset:1024
  s_add_u32 m0, s85, 8192
  s_add_u32 s88, s95, 387072
  buffer_load_dwordx4 v26, s[24:27], s88 offen lds
  s_waitcnt vmcnt(11)
  s_waitcnt lgkmcnt(6)
  v_mfma_f32_32x32x16_bf16 v[72:87], v[40:43], v[184:187], v[72:87]
  ds_read_b64_tr_b16 v[56:57], v32 offset:8192
  ds_read_b64_tr_b16 v[58:59], v32 offset:9216
  buffer_load_dwordx4 v[208:211], v2, s[44:47], s93 offen offset:2048 sc1
  s_waitcnt lgkmcnt(6)
  v_mfma_f32_32x32x16_bf16 v[88:103], v[44:47], v[184:187], v[88:103]
  ds_read_b64_tr_b16 v[60:61], v35 offset:8192
  ds_read_b64_tr_b16 v[62:63], v35 offset:9216
  s_waitcnt vmcnt(10)
  s_waitcnt lgkmcnt(6)
  v_mfma_f32_32x32x16_bf16 v[72:87], v[48:51], v[188:191], v[72:87]
  ds_read_b64_tr_b16 v[64:65], v32 offset:16384
  ds_read_b64_tr_b16 v[66:67], v32 offset:17408
  buffer_load_dwordx4 v[212:215], v2, s[44:47], s93 offen offset:3072 sc1
  s_waitcnt lgkmcnt(6)
  v_mfma_f32_32x32x16_bf16 v[88:103], v[52:55], v[188:191], v[88:103]
  ds_read_b64_tr_b16 v[68:69], v35 offset:16384
  ds_read_b64_tr_b16 v[70:71], v35 offset:17408
  s_barrier
  s_waitcnt vmcnt(9)
  s_waitcnt lgkmcnt(6)
  v_mfma_f32_32x32x16_bf16 v[72:87], v[56:59], v[192:195], v[72:87]
  ds_read_b64_tr_b16 v[40:41], v32 offset:24576
  ds_read_b64_tr_b16 v[42:43], v32 offset:25600
  s_add_u32 s93, s93, 4096
  buffer_load_dwordx4 v[216:219], v2, s[44:47], s93 offen offset:0 sc1
  s_waitcnt lgkmcnt(6)
  v_mfma_f32_32x32x16_bf16 v[88:103], v[60:63], v[192:195], v[88:103]
  ds_read_b64_tr_b16 v[44:45], v35 offset:24576
  ds_read_b64_tr_b16 v[46:47], v35 offset:25600
  s_waitcnt vmcnt(8)
  s_waitcnt lgkmcnt(6)
  v_mfma_f32_32x32x16_bf16 v[72:87], v[64:67], v[196:199], v[72:87]
  ds_read_b64_tr_b16 v[48:49], v32 offset:32768
  ds_read_b64_tr_b16 v[50:51], v32 offset:33792
  buffer_load_dwordx4 v[220:223], v2, s[44:47], s93 offen offset:1024 sc1
  s_waitcnt lgkmcnt(6)
  v_mfma_f32_32x32x16_bf16 v[88:103], v[68:71], v[196:199], v[88:103]
  ds_read_b64_tr_b16 v[52:53], v35 offset:32768
  ds_read_b64_tr_b16 v[54:55], v35 offset:33792
  s_waitcnt vmcnt(7)
  s_waitcnt lgkmcnt(6)
  v_mfma_f32_32x32x16_bf16 v[72:87], v[40:43], v[200:203], v[72:87]
  ds_read_b64_tr_b16 v[56:57], v32 offset:40960
  ds_read_b64_tr_b16 v[58:59], v32 offset:41984
  buffer_load_dwordx4 v[224:227], v2, s[44:47], s93 offen offset:2048 sc1
  s_waitcnt lgkmcnt(6)
  v_mfma_f32_32x32x16_bf16 v[88:103], v[44:47], v[200:203], v[88:103]
  ds_read_b64_tr_b16 v[60:61], v35 offset:40960
  ds_read_b64_tr_b16 v[62:63], v35 offset:41984
  s_waitcnt vmcnt(6)
  s_waitcnt lgkmcnt(6)
  v_mfma_f32_32x32x16_bf16 v[72:87], v[48:51], v[204:207], v[72:87]
  ds_read_b64_tr_b16 v[64:65], v32 offset:49152
  ds_read_b64_tr_b16 v[66:67], v32 offset:50176
  buffer_load_dwordx4 v[228:231], v2, s[44:47], s93 offen offset:3072 sc1
  s_waitcnt lgkmcnt(6)
  v_mfma_f32_32x32x16_bf16 v[88:103], v[52:55], v[204:207], v[88:103]
  ds_read_b64_tr_b16 v[68:69], v35 offset:49152
  ds_read_b64_tr_b16 v[70:71], v35 offset:50176
  s_barrier
  s_waitcnt vmcnt(5)
  s_waitcnt lgkmcnt(6)
  v_mfma_f32_32x32x16_bf16 v[72:87], v[56:59], v[208:211], v[72:87]
  ds_read_b64_tr_b16 v[40:41], v33 offset:0
  ds_read_b64_tr_b16 v[42:43], v33 offset:1024
  s_add_u32 s93, s93, 4096
  buffer_load_dwordx4 v[232:235], v2, s[44:47], s93 offen offset:0 sc1
  s_waitcnt lgkmcnt(6)
  v_mfma_f32_32x32x16_bf16 v[88:103], v[60:63], v[208:211], v[88:103]
  ds_read_b64_tr_b16 v[44:45], v36 offset:0
  ds_read_b64_tr_b16 v[46:47], v36 offset:1024
  s_waitcnt vmcnt(5)
  s_waitcnt lgkmcnt(6)
  v_mfma_f32_32x32x16_bf16 v[72:87], v[64:67], v[212:215], v[72:87]
  ds_read_b64_tr_b16 v[48:49], v33 offset:8192
  ds_read_b64_tr_b16 v[50:51], v33 offset:9216
  buffer_load_dwordx4 v[236:239], v2, s[44:47], s93 offen offset:1024 sc1
  s_waitcnt lgkmcnt(6)
  v_mfma_f32_32x32x16_bf16 v[88:103], v[68:71], v[212:215], v[88:103]
  ds_read_b64_tr_b16 v[52:53], v36 offset:8192
  ds_read_b64_tr_b16 v[54:55], v36 offset:9216
  s_waitcnt vmcnt(5)
  s_waitcnt lgkmcnt(6)
  v_mfma_f32_32x32x16_bf16 v[72:87], v[40:43], v[216:219], v[72:87]
  ds_read_b64_tr_b16 v[56:57], v33 offset:16384
  ds_read_b64_tr_b16 v[58:59], v33 offset:17408
  buffer_load_dwordx4 v[240:243], v2, s[44:47], s93 offen offset:2048 sc1
  s_waitcnt lgkmcnt(6)
  v_mfma_f32_32x32x16_bf16 v[88:103], v[44:47], v[216:219], v[88:103]
  ds_read_b64_tr_b16 v[60:61], v36 offset:16384
  ds_read_b64_tr_b16 v[62:63], v36 offset:17408
  s_waitcnt vmcnt(5)
  s_waitcnt lgkmcnt(6)
  v_mfma_f32_32x32x16_bf16 v[72:87], v[48:51], v[220:223], v[72:87]
  ds_read_b64_tr_b16 v[64:65], v33 offset:24576
  ds_read_b64_tr_b16 v[66:67], v33 offset:25600
  buffer_load_dwordx4 v[244:247], v2, s[44:47], s93 offen offset:3072 sc1
  s_waitcnt lgkmcnt(6)
  v_mfma_f32_32x32x16_bf16 v[88:103], v[52:55], v[220:223], v[88:103]
  ds_read_b64_tr_b16 v[68:69], v36 offset:24576
  ds_read_b64_tr_b16 v[70:71], v36 offset:25600
  s_barrier
  s_waitcnt vmcnt(5)
  s_waitcnt lgkmcnt(6)
  v_mfma_f32_32x32x16_bf16 v[72:87], v[56:59], v[224:227], v[72:87]
  ds_read_b64_tr_b16 v[40:41], v33 offset:32768
  ds_read_b64_tr_b16 v[42:43], v33 offset:33792
  s_waitcnt lgkmcnt(6)
  v_mfma_f32_32x32x16_bf16 v[88:103], v[60:63], v[224:227], v[88:103]
  ds_read_b64_tr_b16 v[44:45], v36 offset:32768
  ds_read_b64_tr_b16 v[46:47], v36 offset:33792
  s_waitcnt vmcnt(4)
  s_waitcnt lgkmcnt(6)
  v_mfma_f32_32x32x16_bf16 v[72:87], v[64:67], v[228:231], v[72:87]
  ds_read_b64_tr_b16 v[48:49], v33 offset:40960
  ds_read_b64_tr_b16 v[50:51], v33 offset:41984
  s_waitcnt lgkmcnt(6)
  v_mfma_f32_32x32x16_bf16 v[88:103], v[68:71], v[228:231], v[88:103]
  ds_read_b64_tr_b16 v[52:53], v36 offset:40960
  ds_read_b64_tr_b16 v[54:55], v36 offset:41984
  s_and_b32 s88, s63, 1
  s_lshl_b32 s88, s88, 6
  s_lshl_b32 s89, s60, 7
  s_add_u32 s88, s88, s89
  s_add_u32 s88, s88, 336640
  v_mul_u32_u24 v14, 896, v9
  buffer_load_dwordx4 v[120:123], v14, s[44:47], s88 offen offset:0 sc1
  buffer_load_dwordx4 v[124:127], v14, s[44:47], s88 offen offset:16 sc1
  buffer_load_dwordx4 v[128:131], v14, s[44:47], s88 offen offset:32 sc1
  buffer_load_dwordx4 v[132:135], v14, s[44:47], s88 offen offset:48 sc1
  s_and_b32 s88, s63, 1
  s_lshl_b32 s88, s88, 11
  s_lshl_b32 s89, s60, 12
  s_add_u32 s88, s88, s89
  s_mul_i32 s89, s92, 28672
  s_add_u32 s88, s88, s89
  s_add_u32 s88, s88, 2490368
  buffer_load_dwordx4 v[200:203], v2, s[44:47], s88 offen offset:0 sc1
  buffer_load_dwordx4 v[204:207], v2, s[44:47], s88 offen offset:1024 sc1
  s_waitcnt vmcnt(9)
  s_waitcnt lgkmcnt(6)
  v_mfma_f32_32x32x16_bf16 v[72:87], v[40:43], v[232:235], v[72:87]
  ds_read_b64_tr_b16 v[56:57], v31 offset:0
  ds_read_b64_tr_b16 v[58:59], v31 offset:1024
  s_waitcnt lgkmcnt(6)
  v_mfma_f32_32x32x16_bf16 v[88:103], v[44:47], v[232:235], v[88:103]
  ds_read_b64_tr_b16 v[60:61], v34 offset:0
  ds_read_b64_tr_b16 v[62:63], v34 offset:1024
  s_waitcnt vmcnt(8)
  s_waitcnt lgkmcnt(6)
  v_mfma_f32_32x32x16_bf16 v[72:87], v[48:51], v[236:239], v[72:87]
  ds_read_b64_tr_b16 v[64:65], v31 offset:8192
  ds_read_b64_tr_b16 v[66:67], v31 offset:9216
  s_waitcnt lgkmcnt(6)
  v_mfma_f32_32x32x16_bf16 v[88:103], v[52:55], v[236:239], v[88:103]
  ds_read_b64_tr_b16 v[68:69], v34 offset:8192
  ds_read_b64_tr_b16 v[70:71], v34 offset:9216
  s_barrier
  s_waitcnt vmcnt(7)
  s_waitcnt lgkmcnt(6)
  v_mfma_f32_32x32x16_bf16 v[72:87], v[56:59], v[240:243], v[72:87]
  s_waitcnt lgkmcnt(4)
  v_mfma_f32_32x32x16_bf16 v[88:103], v[60:63], v[240:243], v[88:103]
  s_waitcnt vmcnt(6)
  s_waitcnt lgkmcnt(0)
  v_mfma_f32_32x32x16_bf16 v[88:103], v[68:71], v[244:247], v[88:103]
  v_mfma_f32_32x32x16_bf16 v[72:87], v[64:67], v[244:247], v[72:87]
  s_and_b32 s88, s52, 3
  s_mul_i32 s89, s88, 12288
  s_xor_b32 s88, s88, 2
  s_mul_i32 s88, s88, 12288
  s_min_u32 s90, s63, 2
  s_lshl_b32 s90, s90, 12
  s_add_u32 s90, s90, 16384
  s_add_u32 s88, s88, s90
  s_add_u32 s90, s89, s90
  v_add_u32 v12, s88, v2
  v_add_u32 v13, s90, v2
  ds_write_b128 v12, v[88:91] offset:0
  ds_write_b128 v12, v[92:95] offset:1024
  ds_write_b128 v12, v[96:99] offset:2048
  ds_write_b128 v12, v[100:103] offset:3072
  s_cmp_ge_u32 s52, 4
  s_cbranch_scc1 L_own
  ds_write_b128 v13, v[72:75] offset:0
  ds_write_b128 v13, v[76:79] offset:1024
  ds_write_b128 v13, v[80:83] offset:2048
  ds_write_b128 v13, v[84:87] offset:3072
  s_waitcnt lgkmcnt(0)
  s_barrier
  s_waitcnt vmcnt(0)
  s_branch L_fin
L_own:
  s_add_u32 s89, s89, 16384
  v_add_u32 v13, s89, v2
  s_mul_i32 s93, s92, 28672
  s_lshl_b32 s89, s60, 7
  s_add_u32 s93, s93, s89
  s_and_b32 s89, s63, 1
  s_lshl_b32 s89, s89, 6
  s_add_u32 s93, s93, s89
  v_and_b32 v15, 31, v1
  v_mul_u32_u24 v15, 896, v15
  v_lshl_add_u32 v15, v9, 4, v15
  s_waitcnt vmcnt(1)
  v_lshlrev_b32 v104, 16, v200
  v_and_b32 v105, 0xffff0000, v200
  v_lshlrev_b32 v106, 16, v201
  v_and_b32 v107, 0xffff0000, v201
  v_lshlrev_b32 v108, 16, v202
  v_and_b32 v109, 0xffff0000, v202
  v_lshlrev_b32 v110, 16, v203
  v_and_b32 v111, 0xffff0000, v203
  s_waitcnt vmcnt(0)
  v_lshlrev_b32 v112, 16, v204
  v_and_b32 v113, 0xffff0000, v204
  v_lshlrev_b32 v114, 16, v205
  v_and_b32 v115, 0xffff0000, v205
  v_lshlrev_b32 v116, 16, v206
  v_and_b32 v117, 0xffff0000, v206
  v_lshlrev_b32 v118, 16, v207
  v_and_b32 v119, 0xffff0000, v207
  v_and_b32 v120, 0xffff0000, v120
  v_and_b32 v121, 0xffff0000, v121
  v_and_b32 v122, 0xffff0000, v122
  v_and_b32 v123, 0xffff0000, v123
  v_and_b32 v124, 0xffff0000, v124
  v_and_b32 v125, 0xffff0000, v125
  v_and_b32 v126, 0xffff0000, v126
  v_and_b32 v127, 0xffff0000, v127
  v_and_b32 v128, 0xffff0000, v128
  v_and_b32 v129, 0xffff0000, v129
  v_and_b32 v130, 0xffff0000, v130
  v_and_b32 v131, 0xffff0000, v131
  v_and_b32 v132, 0xffff0000, v132
  v_and_b32 v133, 0xffff0000, v133
  v_and_b32 v134, 0xffff0000, v134
  v_and_b32 v135, 0xffff0000, v135
  s_waitcnt lgkmcnt(0)
  s_barrier
  ds_read_b128 v[136:139], v13 offset:0
  ds_read_b128 v[140:143], v13 offset:1024
  ds_read_b128 v[144:147], v13 offset:2048
  ds_read_b128 v[148:151], v13 offset:3072
  ds_read_b128 v[152:155], v13 offset:4096
  ds_read_b128 v[156:159], v13 offset:5120
  ds_read_b128 v[160:163], v13 offset:6144
  ds_read_b128 v[164:167], v13 offset:7168
  ds_read_b128 v[168:171], v13 offset:8192
  ds_read_b128 v[172:175], v13 offset:9216
  ds_read_b128 v[176:179], v13 offset:10240
  ds_read_b128 v[180:183], v13 offset:11264
  s_waitcnt lgkmcnt(11)
  v_pk_add_f32 v[72:73], v[72:73], v[136:137]
  v_pk_add_f32 v[74:75], v[74:75], v[138:139]
  s_waitcnt lgkmcnt(10)
  v_pk_add_f32 v[76:77], v[76:77], v[140:141]
  v_pk_add_f32 v[78:79], v[78:79], v[142:143]
  s_waitcnt lgkmcnt(9)
  v_pk_add_f32 v[80:81], v[80:81], v[144:145]
  v_pk_add_f32 v[82:83], v[82:83], v[146:147]
  s_waitcnt lgkmcnt(8)
  v_pk_add_f32 v[84:85], v[84:85], v[148:149]
  v_pk_add_f32 v[86:87], v[86:87], v[150:151]
  s_waitcnt lgkmcnt(7)
  v_pk_add_f32 v[72:73], v[72:73], v[152:153]
  v_pk_add_f32 v[74:75], v[74:75], v[154:155]
  s_waitcnt lgkmcnt(6)
  v_pk_add_f32 v[76:77], v[76:77], v[156:157]
  v_pk_add_f32 v[78:79], v[78:79], v[158:159]
  s_waitcnt lgkmcnt(5)
  v_pk_add_f32 v[80:81], v[80:81], v[160:161]
  v_pk_add_f32 v[82:83], v[82:83], v[162:163]
  s_waitcnt lgkmcnt(4)
  v_pk_add_f32 v[84:85], v[84:85], v[164:165]
  v_pk_add_f32 v[86:87], v[86:87], v[166:167]
  s_waitcnt lgkmcnt(3)
  v_pk_add_f32 v[72:73], v[72:73], v[168:169]
  v_pk_add_f32 v[74:75], v[74:75], v[170:171]
  s_waitcnt lgkmcnt(2)
  v_pk_add_f32 v[76:77], v[76:77], v[172:173]
  v_pk_add_f32 v[78:79], v[78:79], v[174:175]
  s_waitcnt lgkmcnt(1)
  v_pk_add_f32 v[80:81], v[80:81], v[176:177]
  v_pk_add_f32 v[82:83], v[82:83], v[178:179]
  s_waitcnt lgkmcnt(0)
  v_pk_add_f32 v[84:85], v[84:85], v[180:181]
  v_pk_add_f32 v[86:87], v[86:87], v[182:183]
  v_pk_fma_f32 v[72:73], v[72:73], v[120:121], v[104:105]
  v_pk_fma_f32 v[74:75], v[74:75], v[122:123], v[106:107]
  v_pk_fma_f32 v[76:77], v[76:77], v[124:125], v[108:109]
  v_pk_fma_f32 v[78:79], v[78:79], v[126:127], v[110:111]
  v_pk_fma_f32 v[80:81], v[80:81], v[128:129], v[112:113]
  v_pk_fma_f32 v[82:83], v[82:83], v[130:131], v[114:115]
  v_pk_fma_f32 v[84:85], v[84:85], v[132:133], v[116:117]
  v_pk_fma_f32 v[86:87], v[86:87], v[134:135], v[118:119]
  v_cvt_pk_bf16_f32 v40, v72, v73
  v_cvt_pk_bf16_f32 v41, v74, v75
  v_cvt_pk_bf16_f32 v42, v76, v77
  v_cvt_pk_bf16_f32 v43, v78, v79
  v_cvt_pk_bf16_f32 v44, v80, v81
  v_cvt_pk_bf16_f32 v45, v82, v83
  v_cvt_pk_bf16_f32 v46, v84, v85
  v_cvt_pk_bf16_f32 v47, v86, v87
  v_permlane32_swap_b32 v40, v42
  v_permlane32_swap_b32 v41, v43
  v_permlane32_swap_b32 v44, v46
  v_permlane32_swap_b32 v45, v47
  buffer_store_dwordx4 v[40:43], v15, s[36:39], s93 offen offset:0
  buffer_store_dwordx4 v[44:47], v15, s[36:39], s93 offen offset:32
L_fin:
L_end:
  s_endpgm
L_fmain:
  s_waitcnt lgkmcnt(0)
  s_mul_i32 s81, s81, 0x9E3779B1
  s_add_u32 s81, s81, 0x7F4A7C15
  s_and_b32 s2, s81, 0xffff
  s_mov_b32 s14, 401408
  s_mov_b32 s15, 0x20000
  s_mov_b32 s18, 1605632
  s_mov_b32 s19, 0x20000
  s_mov_b32 s22, 1605632
  s_mov_b32 s23, 0x20000
  s_mov_b32 s26, 1605632
  s_mov_b32 s27, 0x20000
  s_mov_b32 s38, 1835008
  s_mov_b32 s39, 0x20000
  s_sub_u32 s50, 31, s54
  s_mul_i32 s98, s53, 7
  s_lshr_b32 s98, s98, 1
  s_add_u32 s51, s50, s98
  s_sub_u32 s98, s51, 28
  s_cmp_ge_u32 s51, 28
  s_cselect_b32 s51, s98, s51
  s_lshr_b32 s58, s54, 4
  s_lshl_b32 s58, s58, 2
  s_add_u32 s58, s58, 1
  s_mul_i32 s59, s50, 37
  s_lshr_b32 s59, s59, 8
  s_mul_i32 s60, s59, 7
  s_sub_u32 s60, s50, s60
  s_mul_i32 s61, s53, 258048
  s_add_u32 s61, s61, 393216
  s_and_b32 s98, s52, 1
  s_lshl_b32 s99, s59, 1
  s_add_u32 s62, s98, s99
  s_lshr_b32 s63, s52, 1
  s_sub_u32 s82, s50, 16
  s_cmp_ge_i32 s82, 7
  s_cselect_b32 s98, 7, 0
  s_cselect_b32 s83, 4, 0
  s_sub_u32 s82, s82, s98
  s_max_i32 s82, s82, 0
  s_min_i32 s82, s82, 6
  s_and_b32 s98, s52, 3
  s_add_u32 s83, s83, s98
  s_and_b32 s93, s57, 1
  s_lshl_b32 s93, s93, 3
  s_add_u32 s93, s93, 77824
  v_lshl_add_u32 v13, v9, 3, v10
  v_mul_u32_u24 v104, 192, v13
  v_lshl_add_u32 v104, v16, 5, v104
  v_lshl_add_u32 v104, v11, 3, v104
  v_add_u32 v104, s93, v104
  v_add_u32 v105, 43008, v104
  v_lshrrev_b32 v12, 4, v1
  v_lshlrev_b32 v12, 2, v12
  v_and_b32 v13, 15, v1
  v_sub_u32 v12, v13, v12
  v_mov_b32 v14, 0xf149f2ca
  v_add_u32 v13, 16, v12
  v_and_b32 v13, 0xfffffff1, v13
  v_cmp_eq_u32 vcc, 0, v13
  s_nop 1
  v_cndmask_b32_e64 v108, v14, 0, vcc
  v_add_u32 v13, 15, v12
  v_and_b32 v13, 0xfffffff1, v13
  v_cmp_eq_u32 vcc, 0, v13
  s_nop 1
  v_cndmask_b32_e64 v109, v14, 0, vcc
  v_add_u32 v13, 14, v12
  v_and_b32 v13, 0xfffffff1, v13
  v_cmp_eq_u32 vcc, 0, v13
  s_nop 1
  v_cndmask_b32_e64 v110, v14, 0, vcc
  v_add_u32 v13, 13, v12
  v_and_b32 v13, 0xfffffff1, v13
  v_cmp_eq_u32 vcc, 0, v13
  s_nop 1
  v_cndmask_b32_e64 v111, v14, 0, vcc
  v_add_u32 v13, 0, v12
  v_and_b32 v13, 0xfffffff1, v13
  v_cmp_eq_u32 vcc, 0, v13
  s_nop 1
  v_cndmask_b32_e64 v112, v14, 0, vcc
  v_add_u32 v13, -1, v12
  v_and_b32 v13, 0xfffffff1, v13
  v_cmp_eq_u32 vcc, 0, v13
  s_nop 1
  v_cndmask_b32_e64 v113, v14, 0, vcc
  v_add_u32 v13, -2, v12
  v_and_b32 v13, 0xfffffff1, v13
  v_cmp_eq_u32 vcc, 0, v13
  s_nop 1
  v_cndmask_b32_e64 v114, v14, 0, vcc
  v_add_u32 v13, -3, v12
  v_and_b32 v13, 0xfffffff1, v13
  v_cmp_eq_u32 vcc, 0, v13
  s_nop 1
  v_cndmask_b32_e64 v115, v14, 0, vcc
  s_add_u32 s88, s58, s52
  s_lshl_b32 s89, s53, 4
  s_add_u32 s89, s89, s88
  s_cmp_eq_u32 s89, 1
  s_cselect_b64 vcc, -1, 0
  v_cndmask_b32 v116, v108, v14, vcc
  v_cndmask_b32 v117, v109, v14, vcc
  v_cndmask_b32 v118, v110, v14, vcc
  v_cndmask_b32 v119, v111, v14, vcc
  s_mov_b32 s99, 1048576
adaLN_cond__sliding_local_dilated__glu_gated_geglu__prompt_kernel_p59:
  ds_read_b32 v8, v18 offset:0
  s_waitcnt lgkmcnt(0)
  v_cmp_gt_u32 vcc, 1, v8
  s_sub_u32 s99, s99, 1
  s_cbranch_scc1 adaLN_cond__sliding_local_dilated__glu_gated_geglu__prompt_kernel_d60
  s_cbranch_vccnz adaLN_cond__sliding_local_dilated__glu_gated_geglu__prompt_kernel_p59
adaLN_cond__sliding_local_dilated__glu_gated_geglu__prompt_kernel_d60:
  v_readfirstlane_b32 s55, v8
  s_nop 0
  s_sub_u32 s55, s55, 1
  s_branch L_p1
L_nogv:
  s_waitcnt lgkmcnt(0)
  s_mul_i32 s81, s81, 0x9E3779B1
  s_add_u32 s81, s81, 0x7F4A7C15
  s_and_b32 s2, s81, 0xffff
  s_mov_b32 s14, 401408
  s_mov_b32 s15, 0x20000
  s_mov_b32 s18, 1605632
  s_mov_b32 s19, 0x20000
  s_mov_b32 s22, 1605632
  s_mov_b32 s23, 0x20000
  s_mov_b32 s26, 1605632
  s_mov_b32 s27, 0x20000
  s_mov_b32 s38, 1835008
  s_mov_b32 s39, 0x20000
  s_sub_u32 s50, 31, s54
  s_mul_i32 s98, s53, 7
  s_lshr_b32 s98, s98, 1
  s_add_u32 s51, s50, s98
  s_sub_u32 s98, s51, 28
  s_cmp_ge_u32 s51, 28
  s_cselect_b32 s51, s98, s51
  s_lshr_b32 s58, s54, 4
  s_lshl_b32 s58, s58, 2
  s_add_u32 s58, s58, 1
  s_mul_i32 s59, s50, 37
  s_lshr_b32 s59, s59, 8
  s_mul_i32 s60, s59, 7
  s_sub_u32 s60, s50, s60
  s_mul_i32 s61, s53, 258048
  s_add_u32 s61, s61, 393216
  s_and_b32 s98, s52, 1
  s_lshl_b32 s99, s59, 1
  s_add_u32 s62, s98, s99
  s_lshr_b32 s63, s52, 1
  s_sub_u32 s82, s50, 16
  s_cmp_ge_i32 s82, 7
  s_cselect_b32 s98, 7, 0
  s_cselect_b32 s83, 4, 0
  s_sub_u32 s82, s82, s98
  s_max_i32 s82, s82, 0
  s_min_i32 s82, s82, 6
  s_and_b32 s98, s52, 3
  s_add_u32 s83, s83, s98
  s_branch L_nogv2
L_fj:
  s_waitcnt lgkmcnt(0)
  s_mul_i32 s81, s81, 0x9E3779B1
  s_add_u32 s81, s81, 0x7F4A7C15
  s_and_b32 s2, s81, 0xffff
  s_mov_b32 s14, 401408
  s_mov_b32 s15, 0x20000
  s_mov_b32 s18, 1605632
  s_mov_b32 s19, 0x20000
  s_mov_b32 s22, 1605632
  s_mov_b32 s23, 0x20000
  s_mov_b32 s26, 1605632
  s_mov_b32 s27, 0x20000
  s_mov_b32 s38, 1835008
  s_mov_b32 s39, 0x20000
  s_sub_u32 s50, 31, s54
  s_mul_i32 s98, s53, 7
  s_lshr_b32 s98, s98, 1
  s_add_u32 s51, s50, s98
  s_sub_u32 s98, s51, 28
  s_cmp_ge_u32 s51, 28
  s_cselect_b32 s51, s98, s51
  s_lshr_b32 s58, s54, 4
  s_lshl_b32 s58, s58, 2
  s_add_u32 s58, s58, 1
  s_mul_i32 s59, s50, 37
  s_lshr_b32 s59, s59, 8
  s_mul_i32 s60, s59, 7
  s_sub_u32 s60, s50, s60
  s_mul_i32 s61, s53, 258048
  s_add_u32 s61, s61, 393216
  s_and_b32 s98, s52, 1
  s_lshl_b32 s99, s59, 1
  s_add_u32 s62, s98, s99
  s_lshr_b32 s63, s52, 1
  s_sub_u32 s82, s50, 16
  s_cmp_ge_i32 s82, 7
  s_cselect_b32 s98, 7, 0
  s_cselect_b32 s83, 4, 0
  s_sub_u32 s82, s82, s98
  s_max_i32 s82, s82, 0
  s_min_i32 s82, s82, 6
  s_and_b32 s98, s52, 3
  s_add_u32 s83, s83, s98
L_nogv2:
  s_setprio 0
  v_lshrrev_b32 v12, 3, v1
  v_mul_u32_u24 v13, 3584, v12
  v_and_b32 v12, 2, v12
  v_and_b32 v14, 7, v1
  v_xor_b32 v14, v14, v12
  v_lshl_add_u32 v24, v14, 4, v13
  v_xor_b32 v14, 4, v14
  v_lshl_add_u32 v25, v14, 4, v13
  s_lshl_b32 s88, s51, 7
  v_add_u32 v24, s88, v24
  v_add_u32 v25, s88, v25
  v_lshl_add_u32 v13, v9, 2, v10
  v_lshlrev_b32 v13, 7, v13
  v_lshl_add_u32 v13, v11, 3, v13
  v_lshrrev_b32 v12, 1, v10
  v_lshl_add_u32 v15, v16, 1, v12
  v_lshlrev_b32 v14, 13, v16
  v_add_u32 v14, v13, v14
  v_lshl_add_u32 v27, v15, 5, v14
  v_xor_b32 v28, 32, v27
  v_xor_b32 v29, 64, v27
  v_xor_b32 v30, 96, v27
  s_and_b32 s88, s63, 1
  v_xor_b32 v12, s88, v12
  v_lshl_add_u32 v13, v12, 6, v13
  v_lshl_add_u32 v13, v16, 5, v13
  s_lshl_b32 s88, s63, 11
  v_add_u32 v31, s88, v13
  v_xor_b32 v34, 64, v31
  v_add_u32 v32, 57344, v31
  v_add_u32 v33, 114688, v31
  v_add_u32 v35, 57344, v34
  v_add_u32 v36, 114688, v34
  v_lshrrev_b32 v12, 3, v1
  v_mul_u32_u24 v26, 896, v12
  v_lshlrev_b32 v12, 1, v12
  v_and_b32 v12, 4, v12
  v_and_b32 v13, 7, v1
  v_xor_b32 v13, v13, v12
  v_lshl_add_u32 v26, v13, 4, v26
  s_lshl_b32 s88, s60, 7
  v_add_u32 v26, s88, v26
  v_lshrrev_b32 v12, 3, v1
  v_mul_u32_u24 v104, 896, v12
  v_lshlrev_b32 v12, 1, v12
  v_and_b32 v12, 4, v12
  v_and_b32 v13, 7, v1
  v_xor_b32 v13, v13, v12
  v_lshl_add_u32 v104, v13, 4, v104
  s_lshl_b32 s88, s82, 7
  v_add_u32 v104, s88, v104
  v_lshrrev_b32 v12, 1, v10
  v_lshlrev_b32 v12, 6, v12
  v_lshl_add_u32 v12, v16, 5, v12
  v_lshl_add_u32 v12, v11, 3, v12
  v_lshl_add_u32 v13, v9, 3, v10
  v_lshl_add_u32 v12, v13, 7, v12
  v_add_u32 v37, 106496, v12
  v_xor_b32 v38, 64, v37
  s_and_b32 s88, s52, 1
  s_mul_i32 s93, s88, 3072
  s_mul_i32 s92, s57, 86016
  s_add_u32 s92, s92, s93
  s_add_u32 s92, s92, 13500416
  s_add_u32 s93, s93, 77824
  s_and_b32 s88, s52, 1
  s_lshl_b32 s88, s88, 2
  v_add_u32 v110, s88, v18
  s_lshl_b32 s89, s57, 7
  s_add_u32 s89, s89, 339968
  s_cmp_lt_u32 s54, 16
  s_cbranch_scc1 L_fwc
  s_cmp_ge_u32 s53, 7
  s_cbranch_scc1 L_fwc
  s_mov_b32 s99, 1048576
adaLN_cond__sliding_local_dilated__glu_gated_geglu__prompt_kernel_p61:
  ds_read_b32 v8, v18 offset:24
  s_waitcnt lgkmcnt(0)
  v_cmp_gt_u32 vcc, 1, v8
  s_sub_u32 s99, s99, 1
  s_cbranch_scc1 adaLN_cond__sliding_local_dilated__glu_gated_geglu__prompt_kernel_d62
  s_cbranch_vccnz adaLN_cond__sliding_local_dilated__glu_gated_geglu__prompt_kernel_p61
adaLN_cond__sliding_local_dilated__glu_gated_geglu__prompt_kernel_d62:
  s_branch L_fwg
L_fwc:
  s_mov_b32 s99, 1048576
adaLN_cond__sliding_local_dilated__glu_gated_geglu__prompt_kernel_p63:
  ds_read_b32 v8, v18 offset:0
  s_waitcnt lgkmcnt(0)
  v_cmp_gt_u32 vcc, 1, v8
  s_sub_u32 s99, s99, 1
  s_cbranch_scc1 adaLN_cond__sliding_local_dilated__glu_gated_geglu__prompt_kernel_d64
  s_cbranch_vccnz adaLN_cond__sliding_local_dilated__glu_gated_geglu__prompt_kernel_p63
adaLN_cond__sliding_local_dilated__glu_gated_geglu__prompt_kernel_d64:
  v_readfirstlane_b32 s55, v8
  s_nop 0
  s_sub_u32 s55, s55, 1
  s_add_u32 s88, s56, 1280
  v_min_u32 v3, 0, v1
  v_lshlrev_b32 v3, 2, v3
  s_mov_b32 s99, 262144
adaLN_cond__sliding_local_dilated__glu_gated_geglu__prompt_kernel_p65:
  buffer_load_dword v8, v3, s[44:47], s88 offen sc1
  s_waitcnt vmcnt(0)
  v_cmp_ne_u32 vcc, 1, v8
  s_nop 0
  s_cbranch_vccz adaLN_cond__sliding_local_dilated__glu_gated_geglu__prompt_kernel_d66
  s_sleep 2
  s_sub_u32 s99, s99, 1
  s_cbranch_scc1 adaLN_cond__sliding_local_dilated__glu_gated_geglu__prompt_kernel_d66
  s_cbranch_vccnz adaLN_cond__sliding_local_dilated__glu_gated_geglu__prompt_kernel_p65
adaLN_cond__sliding_local_dilated__glu_gated_geglu__prompt_kernel_d66:
  s_sub_u32 s88, s50, 16
  s_cmp_ge_u32 s88, 14
  s_cbranch_scc1 adaLN_cond__sliding_local_dilated__glu_gated_geglu__prompt_kernel_ep67
  v_lshrrev_b32 v12, 3, v1
  v_mul_u32_u24 v12, 896, v12
  v_and_b32 v13, 7, v1
  v_lshl_add_u32 v12, v13, 4, v12
  s_lshl_b32 s88, s53, 3
  s_add_u32 s88, s88, s83
  s_mul_i32 s88, s88, 28672
  s_lshl_b32 s98, s82, 7
  s_add_u32 s88, s88, s98
  buffer_load_dwordx4 v[84:87], v12, s[4:7], s88 offen
  s_add_u32 s88, s88, 7168
  buffer_load_dwordx4 v[88:91], v12, s[4:7], s88 offen
  s_add_u32 s88, s88, 7168
  buffer_load_dwordx4 v[92:95], v12, s[4:7], s88 offen
  s_add_u32 s88, s88, 7168
  buffer_load_dwordx4 v[96:99], v12, s[4:7], s88 offen
  s_add_u32 s88, s88, 7168
adaLN_cond__sliding_local_dilated__glu_gated_geglu__prompt_kernel_ep67:
L_fwg:
  v_min_u32 v3, 6, v1
  v_lshlrev_b32 v3, 2, v3
  s_mov_b32 s99, 262144
adaLN_cond__sliding_local_dilated__glu_gated_geglu__prompt_kernel_p68:
  buffer_load_dword v8, v3, s[44:47], s89 offen sc1
  s_waitcnt vmcnt(0)
  v_cmp_ne_u32 vcc, s81, v8
  s_nop 0
  s_cbranch_vccz adaLN_cond__sliding_local_dilated__glu_gated_geglu__prompt_kernel_d69
  s_sleep 8
  s_sub_u32 s99, s99, 1
  s_cbranch_scc1 adaLN_cond__sliding_local_dilated__glu_gated_geglu__prompt_kernel_d69
  s_cbranch_vccnz adaLN_cond__sliding_local_dilated__glu_gated_geglu__prompt_kernel_p68
adaLN_cond__sliding_local_dilated__glu_gated_geglu__prompt_kernel_d69:
  s_mov_b32 s99, 1048576
adaLN_cond__sliding_local_dilated__glu_gated_geglu__prompt_kernel_p70:
  ds_read_b32 v8, v18 offset:0
  s_waitcnt lgkmcnt(0)
  v_cmp_gt_u32 vcc, 1, v8
  s_sub_u32 s99, s99, 1
  s_cbranch_scc1 adaLN_cond__sliding_local_dilated__glu_gated_geglu__prompt_kernel_d71
  s_cbranch_vccnz adaLN_cond__sliding_local_dilated__glu_gated_geglu__prompt_kernel_p70
adaLN_cond__sliding_local_dilated__glu_gated_geglu__prompt_kernel_d71:
  v_readfirstlane_b32 s55, v8
  s_nop 0
  s_sub_u32 s55, s55, 1
  s_add_u32 s88, s92, 0
  s_add_u32 m0, s93, 0
  s_nop 0
  buffer_load_dwordx4 v2, s[44:47], s88 offen offset:0 sc1 lds
  buffer_load_dwordx4 v2, s[44:47], s88 offen offset:1024 sc1 lds
  buffer_load_dwordx4 v2, s[44:47], s88 offen offset:2048 sc1 lds
  s_add_u32 s88, s92, 6144
  s_add_u32 m0, s93, 6144
  s_nop 0
  buffer_load_dwordx4 v2, s[44:47], s88 offen offset:0 sc1 lds
  buffer_load_dwordx4 v2, s[44:47], s88 offen offset:1024 sc1 lds
  buffer_load_dwordx4 v2, s[44:47], s88 offen offset:2048 sc1 lds
  s_cmp_ge_u32 s54, 16
  s_cbranch_scc1 L_str
  s_waitcnt vmcnt(0)
  v_mov_b32 v20, 2
  ds_write_b32 v110, v20 offset:8
  s_lshl_b32 s89, s54, 6
  s_add_u32 s89, s89, s56
  s_add_u32 s89, s89, 128
  v_min_u32 v3, 15, v1
  v_lshlrev_b32 v3, 2, v3
  s_mov_b32 s99, 262144
adaLN_cond__sliding_local_dilated__glu_gated_geglu__prompt_kernel_p72:
  buffer_load_dword v8, v3, s[44:47], s89 offen sc1
  s_waitcnt vmcnt(0)
  v_cmp_ne_u32 vcc, 1, v8
  s_sub_u32 s99, s99, 1
  s_cbranch_scc1 adaLN_cond__sliding_local_dilated__glu_gated_geglu__prompt_kernel_d73
  s_cbranch_vccnz adaLN_cond__sliding_local_dilated__glu_gated_geglu__prompt_kernel_p72
adaLN_cond__sliding_local_dilated__glu_gated_geglu__prompt_kernel_d73:
  s_cmp_lt_u32 s54, 14
  s_cbranch_scc1 L_str
  s_add_u32 s89, s56, 64
  v_min_u32 v3, 15, v1
  v_lshlrev_b32 v3, 2, v3
  s_mov_b32 s99, 262144
adaLN_cond__sliding_local_dilated__glu_gated_geglu__prompt_kernel_p74:
  buffer_load_dword v8, v3, s[44:47], s89 offen sc1
  s_waitcnt vmcnt(0)
  v_cmp_ne_u32 vcc, 1, v8
  s_sub_u32 s99, s99, 1
  s_cbranch_scc1 adaLN_cond__sliding_local_dilated__glu_gated_geglu__prompt_kernel_d75
  s_cbranch_vccnz adaLN_cond__sliding_local_dilated__glu_gated_geglu__prompt_kernel_p74
adaLN_cond__sliding_local_dilated__glu_gated_geglu__prompt_kernel_d75:
L_str:
  s_add_u32 s88, s92, 12288
  s_add_u32 m0, s93, 12288
  s_nop 0
  buffer_load_dwordx4 v2, s[44:47], s88 offen offset:0 sc1 lds
  buffer_load_dwordx4 v2, s[44:47], s88 offen offset:1024 sc1 lds
  buffer_load_dwordx4 v2, s[44:47], s88 offen offset:2048 sc1 lds
  s_add_u32 s88, s92, 18432
  s_add_u32 m0, s93, 18432
  s_nop 0
  buffer_load_dwordx4 v2, s[44:47], s88 offen offset:0 sc1 lds
  buffer_load_dwordx4 v2, s[44:47], s88 offen offset:1024 sc1 lds
  buffer_load_dwordx4 v2, s[44:47], s88 offen offset:2048 sc1 lds
  s_add_u32 s88, s92, 24576
  s_add_u32 m0, s93, 24576
  s_nop 0
  buffer_load_dwordx4 v2, s[44:47], s88 offen offset:0 sc1 lds
  buffer_load_dwordx4 v2, s[44:47], s88 offen offset:1024 sc1 lds
  buffer_load_dwordx4 v2, s[44:47], s88 offen offset:2048 sc1 lds
  s_waitcnt vmcnt(9)
  v_mov_b32 v20, 2
  ds_write_b32 v110, v20 offset:8
  s_add_u32 s88, s92, 30720
  s_add_u32 m0, s93, 30720
  s_nop 0
  buffer_load_dwordx4 v2, s[44:47], s88 offen offset:0 sc1 lds
  buffer_load_dwordx4 v2, s[44:47], s88 offen offset:1024 sc1 lds
  buffer_load_dwordx4 v2, s[44:47], s88 offen offset:2048 sc1 lds
  s_waitcnt vmcnt(9)
  v_mov_b32 v20, 3
  ds_write_b32 v110, v20 offset:8
  s_add_u32 s88, s92, 36864
  s_add_u32 m0, s93, 36864
  s_nop 0
  buffer_load_dwordx4 v2, s[44:47], s88 offen offset:0 sc1 lds
  buffer_load_dwordx4 v2, s[44:47], s88 offen offset:1024 sc1 lds
  buffer_load_dwordx4 v2, s[44:47], s88 offen offset:2048 sc1 lds
  s_lshl_b32 s88, s54, 9
  s_add_u32 s88, s88, s56
  s_add_u32 s88, s88, 8192
  s_mov_b64 exec, 0xf
  buffer_load_dword v255, v17, s[44:47], s88 offen
  s_lshl_b32 s88, s54, 7
  s_add_u32 s88, s88, s56
  s_mov_b64 exec, 1
  buffer_load_dword v255, v17, s[44:47], s88 offen
  s_mov_b64 exec, -1
  s_waitcnt vmcnt(11)
  v_mov_b32 v20, 4
  ds_write_b32 v110, v20 offset:8
  s_add_u32 s88, s92, 43008
  s_add_u32 m0, s93, 43008
  s_nop 0
  buffer_load_dwordx4 v2, s[44:47], s88 offen offset:0 sc1 lds
  buffer_load_dwordx4 v2, s[44:47], s88 offen offset:1024 sc1 lds
  buffer_load_dwordx4 v2, s[44:47], s88 offen offset:2048 sc1 lds
  s_waitcnt vmcnt(11)
  v_mov_b32 v20, 5
  ds_write_b32 v110, v20 offset:8
  s_add_u32 s88, s92, 49152
  s_add_u32 m0, s93, 49152
  s_nop 0
  buffer_load_dwordx4 v2, s[44:47], s88 offen offset:0 sc1 lds
  buffer_load_dwordx4 v2, s[44:47], s88 offen offset:1024 sc1 lds
  buffer_load_dwordx4 v2, s[44:47], s88 offen offset:2048 sc1 lds
  s_waitcnt vmcnt(11)
  v_mov_b32 v20, 6
  ds_write_b32 v110, v20 offset:8
  s_add_u32 s88, s92, 55296
  s_add_u32 m0, s93, 55296
  s_nop 0
  buffer_load_dwordx4 v2, s[44:47], s88 offen offset:0 sc1 lds
  buffer_load_dwordx4 v2, s[44:47], s88 offen offset:1024 sc1 lds
  buffer_load_dwordx4 v2, s[44:47], s88 offen offset:2048 sc1 lds
  s_waitcnt vmcnt(11)
  v_mov_b32 v20, 7
  ds_write_b32 v110, v20 offset:8
  s_add_u32 s88, s92, 61440
  s_add_u32 m0, s93, 61440
  s_nop 0
  buffer_load_dwordx4 v2, s[44:47], s88 offen offset:0 sc1 lds
  buffer_load_dwordx4 v2, s[44:47], s88 offen offset:1024 sc1 lds
  buffer_load_dwordx4 v2, s[44:47], s88 offen offset:2048 sc1 lds
  s_waitcnt vmcnt(9)
  v_mov_b32 v20, 8
  ds_write_b32 v110, v20 offset:8
  s_add_u32 s88, s92, 67584
  s_add_u32 m0, s93, 67584
  s_nop 0
  buffer_load_dwordx4 v2, s[44:47], s88 offen offset:0 sc1 lds
  buffer_load_dwordx4 v2, s[44:47], s88 offen offset:1024 sc1 lds
  buffer_load_dwordx4 v2, s[44:47], s88 offen offset:2048 sc1 lds
  s_waitcnt vmcnt(9)
  v_mov_b32 v20, 9
  ds_write_b32 v110, v20 offset:8
  s_add_u32 s88, s92, 73728
  s_add_u32 m0, s93, 73728
  s_nop 0
  buffer_load_dwordx4 v2, s[44:47], s88 offen offset:0 sc1 lds
  buffer_load_dwordx4 v2, s[44:47], s88 offen offset:1024 sc1 lds
  buffer_load_dwordx4 v2, s[44:47], s88 offen offset:2048 sc1 lds
  s_waitcnt vmcnt(9)
  v_mov_b32 v20, 10
  ds_write_b32 v110, v20 offset:8
  s_add_u32 s88, s92, 79872
  s_add_u32 m0, s93, 79872
  s_nop 0
  buffer_load_dwordx4 v2, s[44:47], s88 offen offset:0 sc1 lds
  buffer_load_dwordx4 v2, s[44:47], s88 offen offset:1024 sc1 lds
  buffer_load_dwordx4 v2, s[44:47], s88 offen offset:2048 sc1 lds
  s_waitcnt vmcnt(9)
  v_mov_b32 v20, 11
  ds_write_b32 v110, v20 offset:8
  s_waitcnt vmcnt(6)
  v_mov_b32 v20, 12
  ds_write_b32 v110, v20 offset:8
  s_waitcnt vmcnt(3)
  v_mov_b32 v20, 13
  ds_write_b32 v110, v20 offset:8
  s_waitcnt vmcnt(0)
  v_mov_b32 v20, 14
  ds_write_b32 v110, v20 offset:8
  v_mov_b32 v200, 0
  v_mov_b32 v201, 0
  v_mov_b32 v202, 0
  v_mov_b32 v203, 0
  s_lshl_b32 s88, s54, 9
  s_add_u32 s88, s88, s56
  s_add_u32 s88, s88, 8192
  s_cmp_lg_u32 s55, 0
  s_cbranch_scc1 adaLN_cond__sliding_local_dilated__glu_gated_geglu__prompt_kernel_m76
  s_mov_b32 exec_hi, 0
  buffer_store_dwordx4 v[200:203], v2, s[44:47], s88 offen
  s_mov_b32 exec_hi, -1
adaLN_cond__sliding_local_dilated__glu_gated_geglu__prompt_kernel_e77:
  s_sub_u32 s88, s50, 16
  s_cmp_ge_u32 s88, 14
  s_cbranch_scc1 adaLN_cond__sliding_local_dilated__glu_gated_geglu__prompt_kernel_ep78
  v_lshrrev_b32 v12, 3, v1
  v_mul_u32_u24 v12, 896, v12
  v_and_b32 v13, 7, v1
  v_lshl_add_u32 v12, v13, 4, v12
  s_lshl_b32 s88, s82, 7
  s_add_u32 s88, s88, 331264
  buffer_load_dwordx4 v[100:103], v12, s[44:47], s88 offen sc1
adaLN_cond__sliding_local_dilated__glu_gated_geglu__prompt_kernel_ep78:
  s_waitcnt vmcnt(0)
  ds_read_b64 v[20:21], v18 offset:8
  s_waitcnt lgkmcnt(0)
  v_min_u32 v20, v20, v21
  v_cmp_gt_u32 vcc, 1, v20
  s_nop 0
  s_cbranch_vccnz adaLN_cond__sliding_local_dilated__glu_gated_geglu__prompt_kernel_g79
adaLN_cond__sliding_local_dilated__glu_gated_geglu__prompt_kernel_h80:
  s_cmp_ge_u32 s50, 16
  s_cbranch_scc1 adaLN_cond__sliding_local_dilated__glu_gated_geglu__prompt_kernel_w181
  s_lshl_b32 s91, s50, 1
  s_and_b32 s88, s52, 1
  s_add_u32 s91, s91, s88
  s_mul_i32 s88, s91, 12544
  s_add_u32 s88, s88, 0
  buffer_load_dword v255, v17, s[12:15], s88 offen
  s_add_u32 s88, s88, 8192
  s_mov_b32 exec_lo, 4294967295
  s_mov_b32 exec_hi, 3
  buffer_load_dword v255, v17, s[12:15], s88 offen
  s_mov_b64 exec, -1
  s_mul_i32 s88, s91, 7168
  s_add_u32 s88, s88, 2490368
  s_mul_i32 s89, s53, 229376
  s_add_u32 s88, s88, s89
  s_mov_b32 exec_lo, 4294967295
  s_mov_b32 exec_hi, 16777215
  buffer_load_dword v255, v17, s[44:47], s88 offen
  s_mov_b64 exec, -1
adaLN_cond__sliding_local_dilated__glu_gated_geglu__prompt_kernel_w181:
  s_cmp_ge_u32 s50, 28
  s_cbranch_scc1 adaLN_cond__sliding_local_dilated__glu_gated_geglu__prompt_kernel_w282
  s_and_b32 s91, s52, 1
  s_mul_i32 s89, s91, 28672
  s_lshl_b32 s88, s91, 10
  s_add_u32 m0, s88, 0
  s_add_u32 s90, s89, 0
  buffer_load_dwordx4 v24, s[16:19], s90 offen lds
  s_add_u32 m0, s88, 2048
  s_add_u32 s90, s89, 57344
  buffer_load_dwordx4 v24, s[16:19], s90 offen lds
  s_add_u32 m0, s88, 4096
  s_add_u32 s90, s89, 114688
  buffer_load_dwordx4 v24, s[16:19], s90 offen lds
  s_add_u32 m0, s88, 6144
  s_add_u32 s90, s89, 172032
  buffer_load_dwordx4 v24, s[16:19], s90 offen lds
  s_add_u32 m0, s88, 8192
  s_add_u32 s90, s89, 0
  buffer_load_dwordx4 v25, s[20:23], s90 offen lds
  s_add_u32 m0, s88, 10240
  s_add_u32 s90, s89, 57344
  buffer_load_dwordx4 v25, s[20:23], s90 offen lds
  s_add_u32 m0, s88, 12288
  s_add_u32 s90, s89, 114688
  buffer_load_dwordx4 v25, s[20:23], s90 offen lds
  s_add_u32 m0, s88, 14336
  s_add_u32 s90, s89, 172032
  buffer_load_dwordx4 v25, s[20:23], s90 offen lds
  s_add_u32 m0, s88, 16384
  s_add_u32 s90, s89, 229376
  buffer_load_dwordx4 v24, s[16:19], s90 offen lds
  s_add_u32 m0, s88, 18432
  s_add_u32 s90, s89, 286720
  buffer_load_dwordx4 v24, s[16:19], s90 offen lds
  s_add_u32 m0, s88, 20480
  s_add_u32 s90, s89, 344064
  buffer_load_dwordx4 v24, s[16:19], s90 offen lds
  s_add_u32 m0, s88, 22528
  s_add_u32 s90, s89, 401408
  buffer_load_dwordx4 v24, s[16:19], s90 offen lds
  s_add_u32 m0, s88, 24576
  s_add_u32 s90, s89, 229376
  buffer_load_dwordx4 v25, s[20:23], s90 offen lds
  s_add_u32 m0, s88, 26624
  s_add_u32 s90, s89, 286720
  buffer_load_dwordx4 v25, s[20:23], s90 offen lds
  s_add_u32 m0, s88, 28672
  s_add_u32 s90, s89, 344064
  buffer_load_dwordx4 v25, s[20:23], s90 offen lds
  s_add_u32 m0, s88, 30720
  s_add_u32 s90, s89, 401408
  buffer_load_dwordx4 v25, s[20:23], s90 offen lds
adaLN_cond__sliding_local_dilated__glu_gated_geglu__prompt_kernel_w282:
L_h45j:
  s_waitcnt lgkmcnt(0)
  s_branch L_ha
L_h67m:
  s_waitcnt lgkmcnt(0)
  s_mul_i32 s81, s81, 0x9E3779B1
  s_add_u32 s81, s81, 0x7F4A7C15
  s_and_b32 s2, s81, 0xffff
  s_mov_b32 s14, 401408
  s_mov_b32 s15, 0x20000
  s_mov_b32 s18, 1605632
  s_mov_b32 s19, 0x20000
  s_mov_b32 s22, 1605632
  s_mov_b32 s23, 0x20000
  s_mov_b32 s26, 1605632
  s_mov_b32 s27, 0x20000
  s_mov_b32 s38, 1835008
  s_mov_b32 s39, 0x20000
  s_sub_u32 s50, 31, s54
  s_mul_i32 s98, s53, 7
  s_lshr_b32 s98, s98, 1
  s_add_u32 s51, s50, s98
  s_sub_u32 s98, s51, 28
  s_cmp_ge_u32 s51, 28
  s_cselect_b32 s51, s98, s51
  s_lshr_b32 s58, s54, 4
  s_lshl_b32 s58, s58, 2
  s_add_u32 s58, s58, 1
  s_mul_i32 s59, s50, 37
  s_lshr_b32 s59, s59, 8
  s_mul_i32 s60, s59, 7
  s_sub_u32 s60, s50, s60
  s_mul_i32 s61, s53, 258048
  s_add_u32 s61, s61, 393216
  s_and_b32 s98, s52, 1
  s_lshl_b32 s99, s59, 1
  s_add_u32 s62, s98, s99
  s_lshr_b32 s63, s52, 1
  s_sub_u32 s82, s50, 16
  s_cmp_ge_i32 s82, 7
  s_cselect_b32 s98, 7, 0
  s_cselect_b32 s83, 4, 0
  s_sub_u32 s82, s82, s98
  s_max_i32 s82, s82, 0
  s_min_i32 s82, s82, 6
  s_and_b32 s98, s52, 3
  s_add_u32 s83, s83, s98
  s_mov_b32 s99, 1048576
adaLN_cond__sliding_local_dilated__glu_gated_geglu__prompt_kernel_p83:
  ds_read_b32 v8, v18 offset:0
  s_waitcnt lgkmcnt(0)
  v_cmp_gt_u32 vcc, 1, v8
  s_sub_u32 s99, s99, 1
  s_cbranch_scc1 adaLN_cond__sliding_local_dilated__glu_gated_geglu__prompt_kernel_d84
  s_cbranch_vccnz adaLN_cond__sliding_local_dilated__glu_gated_geglu__prompt_kernel_p83
adaLN_cond__sliding_local_dilated__glu_gated_geglu__prompt_kernel_d84:
  v_readfirstlane_b32 s55, v8
  s_nop 0
  s_sub_u32 s55, s55, 1
L_h67j:
  v_lshrrev_b32 v12, 3, v1
  v_mul_u32_u24 v13, 3584, v12
  v_and_b32 v12, 2, v12
  v_and_b32 v14, 7, v1
  v_xor_b32 v14, v14, v12
  v_lshl_add_u32 v24, v14, 4, v13
  v_xor_b32 v14, 4, v14
  v_lshl_add_u32 v25, v14, 4, v13
  s_lshl_b32 s88, s51, 7
  v_add_u32 v24, s88, v24
  v_add_u32 v25, s88, v25
  v_lshl_add_u32 v13, v9, 2, v10
  v_lshlrev_b32 v13, 7, v13
  v_lshl_add_u32 v13, v11, 3, v13
  v_lshrrev_b32 v12, 1, v10
  v_lshl_add_u32 v15, v16, 1, v12
  v_lshlrev_b32 v14, 13, v16
  v_add_u32 v14, v13, v14
  v_lshl_add_u32 v27, v15, 5, v14
  v_xor_b32 v28, 32, v27
  v_xor_b32 v29, 64, v27
  v_xor_b32 v30, 96, v27
  s_and_b32 s88, s63, 1
  v_xor_b32 v12, s88, v12
  v_lshl_add_u32 v13, v12, 6, v13
  v_lshl_add_u32 v13, v16, 5, v13
  s_lshl_b32 s88, s63, 11
  v_add_u32 v31, s88, v13
  v_xor_b32 v34, 64, v31
  v_add_u32 v32, 57344, v31
  v_add_u32 v33, 114688, v31
  v_add_u32 v35, 57344, v34
  v_add_u32 v36, 114688, v34
  v_lshrrev_b32 v12, 3, v1
  v_mul_u32_u24 v26, 896, v12
  v_lshlrev_b32 v12, 1, v12
  v_and_b32 v12, 4, v12
  v_and_b32 v13, 7, v1
  v_xor_b32 v13, v13, v12
  v_lshl_add_u32 v26, v13, 4, v26
  s_lshl_b32 s88, s60, 7
  v_add_u32 v26, s88, v26
  v_lshrrev_b32 v12, 3, v1
  v_mul_u32_u24 v104, 896, v12
  v_lshlrev_b32 v12, 1, v12
  v_and_b32 v12, 4, v12
  v_and_b32 v13, 7, v1
  v_xor_b32 v13, v13, v12
  v_lshl_add_u32 v104, v13, 4, v104
  s_lshl_b32 s88, s82, 7
  v_add_u32 v104, s88, v104
  v_lshrrev_b32 v12, 1, v10
  v_lshlrev_b32 v12, 6, v12
  v_lshl_add_u32 v12, v16, 5, v12
  v_lshl_add_u32 v12, v11, 3, v12
  v_lshl_add_u32 v13, v9, 3, v10
  v_lshl_add_u32 v12, v13, 7, v12
  v_add_u32 v37, 106496, v12
  v_xor_b32 v38, 64, v37
  s_sub_u32 s88, s58, 1
  s_lshl_b32 s89, s88, 7
  s_add_u32 s89, s89, s56
  s_add_u32 s89, s89, 64
  s_and_b32 s91, s52, 1
  s_mul_i32 s93, s88, 28672
  s_add_u32 s93, s93, s61
  s_add_u32 s93, s93, 256
  s_lshl_b32 s88, s91, 11
  s_add_u32 s93, s93, s88
  v_lshrrev_b32 v15, 4, v1
  v_and_b32 v14, 15, v1
  v_lshlrev_b32 v110, 9, v15
  v_lshl_add_u32 v110, v14, 4, v110
  s_and_b32 s90, s57, 1
  s_lshl_b32 s90, s90, 3
  s_mul_i32 s91, s91, 6144
  s_add_u32 s90, s90, s91
  s_add_u32 s90, s90, 77824
  v_lshl_add_u32 v13, v15, 3, v10
  v_mul_u32_u24 v108, 192, v13
  v_lshl_add_u32 v108, v11, 3, v108
  v_add_u32 v108, s90, v108
  v_add_u32 v109, 49152, v2
  s_add_u32 s90, s56, 1280
  v_min_u32 v3, 0, v1
  v_lshlrev_b32 v3, 2, v3
  s_mov_b32 s99, 262144
adaLN_cond__sliding_local_dilated__glu_gated_geglu__prompt_kernel_p85:
  buffer_load_dword v8, v3, s[44:47], s90 offen sc1
  s_waitcnt vmcnt(0)
  v_cmp_ne_u32 vcc, 1, v8
  s_nop 0
  s_cbranch_vccz adaLN_cond__sliding_local_dilated__glu_gated_geglu__prompt_kernel_d86
  s_sleep 2
  s_sub_u32 s99, s99, 1
  s_cbranch_scc1 adaLN_cond__sliding_local_dilated__glu_gated_geglu__prompt_kernel_d86
  s_cbranch_vccnz adaLN_cond__sliding_local_dilated__glu_gated_geglu__prompt_kernel_p85
adaLN_cond__sliding_local_dilated__glu_gated_geglu__prompt_kernel_d86:
  s_sub_u32 s88, s50, 16
  s_cmp_ge_u32 s88, 14
  s_cbranch_scc1 adaLN_cond__sliding_local_dilated__glu_gated_geglu__prompt_kernel_ep87
  v_lshrrev_b32 v12, 3, v1
  v_mul_u32_u24 v12, 896, v12
  v_and_b32 v13, 7, v1
  v_lshl_add_u32 v12, v13, 4, v12
  s_lshl_b32 s88, s53, 3
  s_add_u32 s88, s88, s83
  s_mul_i32 s88, s88, 28672
  s_lshl_b32 s98, s82, 7
  s_add_u32 s88, s88, s98
  buffer_load_dwordx4 v[84:87], v12, s[4:7], s88 offen
  s_add_u32 s88, s88, 7168
  buffer_load_dwordx4 v[88:91], v12, s[4:7], s88 offen
  s_add_u32 s88, s88, 7168
  buffer_load_dwordx4 v[92:95], v12, s[4:7], s88 offen
  s_add_u32 s88, s88, 7168
  buffer_load_dwordx4 v[96:99], v12, s[4:7], s88 offen
  s_add_u32 s88, s88, 7168
adaLN_cond__sliding_local_dilated__glu_gated_geglu__prompt_kernel_ep87:
  v_min_u32 v3, 15, v1
  v_lshlrev_b32 v3, 2, v3
  s_mov_b32 s99, 262144
adaLN_cond__sliding_local_dilated__glu_gated_geglu__prompt_kernel_p88:
  buffer_load_dword v8, v3, s[44:47], s89 offen sc1
  s_waitcnt vmcnt(0)
  v_cmp_ne_u32 vcc, 1, v8
  s_nop 0
  s_cbranch_vccz adaLN_cond__sliding_local_dilated__glu_gated_geglu__prompt_kernel_d89
  s_sleep 1
  s_sub_u32 s99, s99, 1
  s_cbranch_scc1 adaLN_cond__sliding_local_dilated__glu_gated_geglu__prompt_kernel_d89
  s_cbranch_vccnz adaLN_cond__sliding_local_dilated__glu_gated_geglu__prompt_kernel_p88
adaLN_cond__sliding_local_dilated__glu_gated_geglu__prompt_kernel_d89:
  buffer_load_dwordx4 v[144:147], v110, s[44:47], s93 offen sc1
  s_add_u32 s93, s93, 4096
  buffer_load_dwordx4 v[148:151], v110, s[44:47], s93 offen sc1
  s_add_u32 s93, s93, 4096
  buffer_load_dwordx4 v[152:155], v110, s[44:47], s93 offen sc1
  s_add_u32 s93, s93, 4096
  buffer_load_dwordx4 v[156:159], v110, s[44:47], s93 offen sc1
  s_add_u32 s93, s93, 4096
  buffer_load_dwordx4 v[160:163], v110, s[44:47], s93 offen sc1
  s_add_u32 s93, s93, 4096
  buffer_load_dwordx4 v[164:167], v110, s[44:47], s93 offen sc1
  s_add_u32 s93, s93, 4096
  buffer_load_dwordx4 v[168:171], v110, s[44:47], s93 offen sc1
  ds_read_b64 v[20:21], v18 offset:8
  s_cmp_eq_u32 s52, 7
  s_cbranch_scc1 L_hv
  s_waitcnt lgkmcnt(0)
  v_min_u32 v20, v20, v21
  v_cmp_gt_u32 vcc, 1, v20
  s_nop 0
  s_cbranch_vccnz adaLN_cond__sliding_local_dilated__glu_gated_geglu__prompt_kernel_g90
adaLN_cond__sliding_local_dilated__glu_gated_geglu__prompt_kernel_h91:
  ds_read_b64_tr_b16 v[128:129], v108 offset:64
  ds_read_b64_tr_b16 v[130:131], v108 offset:832
  ds_read_b64_tr_b16 v[132:133], v108 offset:96
  ds_read_b64_tr_b16 v[134:135], v108 offset:864
  ds_read_b64_tr_b16 v[136:137], v108 offset:128
  ds_read_b64_tr_b16 v[138:139], v108 offset:896
  ds_read_b64_tr_b16 v[140:141], v108 offset:160
  ds_read_b64_tr_b16 v[142:143], v108 offset:928
  ds_read_b64 v[20:21], v18 offset:8
  s_waitcnt lgkmcnt(0)
  v_min_u32 v20, v20, v21
  v_cmp_gt_u32 vcc, 3, v20
  s_nop 0
  s_cbranch_vccnz adaLN_cond__sliding_local_dilated__glu_gated_geglu__prompt_kernel_g92
adaLN_cond__sliding_local_dilated__glu_gated_geglu__prompt_kernel_h93:
  ds_read_b64_tr_b16 v[212:213], v108 offset:12352
  ds_read_b64_tr_b16 v[214:215], v108 offset:13120
  ds_read_b64_tr_b16 v[216:217], v108 offset:12384
  ds_read_b64_tr_b16 v[218:219], v108 offset:13152
  ds_read_b64_tr_b16 v[220:221], v108 offset:12416
  ds_read_b64_tr_b16 v[222:223], v108 offset:13184
  ds_read_b64_tr_b16 v[224:225], v108 offset:12448
  ds_read_b64_tr_b16 v[226:227], v108 offset:13216
  ds_read_b64 v[20:21], v18 offset:8
  s_waitcnt vmcnt(6)
  v_mfma_f32_16x16x32_bf16 v[112:115], v[128:131], v[144:147], 0
  v_mfma_f32_16x16x32_bf16 v[116:119], v[132:135], v[144:147], 0
  v_mfma_f32_16x16x32_bf16 v[120:123], v[144:147], v[136:139], 0
  v_mfma_f32_16x16x32_bf16 v[124:127], v[144:147], v[140:143], 0
  s_waitcnt lgkmcnt(0)
  v_min_u32 v20, v20, v21
  v_cmp_gt_u32 vcc, 5, v20
  s_nop 0
  s_cbranch_vccnz adaLN_cond__sliding_local_dilated__glu_gated_geglu__prompt_kernel_g94
adaLN_cond__sliding_local_dilated__glu_gated_geglu__prompt_kernel_h95:
  ds_read_b64_tr_b16 v[128:129], v108 offset:24640
  ds_read_b64_tr_b16 v[130:131], v108 offset:25408
  ds_read_b64_tr_b16 v[132:133], v108 offset:24672
  ds_read_b64_tr_b16 v[134:135], v108 offset:25440
  ds_read_b64_tr_b16 v[136:137], v108 offset:24704
  ds_read_b64_tr_b16 v[138:139], v108 offset:25472
  ds_read_b64_tr_b16 v[140:141], v108 offset:24736
  ds_read_b64_tr_b16 v[142:143], v108 offset:25504
  ds_read_b64 v[20:21], v18 offset:8
  s_waitcnt vmcnt(5)
  v_mfma_f32_16x16x32_bf16 v[112:115], v[212:215], v[148:151], v[112:115]
  v_mfma_f32_16x16x32_bf16 v[116:119], v[216:219], v[148:151], v[116:119]
  v_mfma_f32_16x16x32_bf16 v[120:123], v[148:151], v[220:223], v[120:123]
  v_mfma_f32_16x16x32_bf16 v[124:127], v[148:151], v[224:227], v[124:127]
  s_waitcnt lgkmcnt(0)
  v_min_u32 v20, v20, v21
  v_cmp_gt_u32 vcc, 7, v20
  s_nop 0
  s_cbranch_vccnz adaLN_cond__sliding_local_dilated__glu_gated_geglu__prompt_kernel_g96
adaLN_cond__sliding_local_dilated__glu_gated_geglu__prompt_kernel_h97:
  ds_read_b64_tr_b16 v[212:213], v108 offset:36928
  ds_read_b64_tr_b16 v[214:215], v108 offset:37696
  ds_read_b64_tr_b16 v[216:217], v108 offset:36960
  ds_read_b64_tr_b16 v[218:219], v108 offset:37728
  ds_read_b64_tr_b16 v[220:221], v108 offset:36992
  ds_read_b64_tr_b16 v[222:223], v108 offset:37760
  ds_read_b64_tr_b16 v[224:225], v108 offset:37024
  ds_read_b64_tr_b16 v[226:227], v108 offset:37792
  ds_read_b64 v[20:21], v18 offset:8
  s_waitcnt vmcnt(4)
  v_mfma_f32_16x16x32_bf16 v[112:115], v[128:131], v[152:155], v[112:115]
  v_mfma_f32_16x16x32_bf16 v[116:119], v[132:135], v[152:155], v[116:119]
  v_mfma_f32_16x16x32_bf16 v[120:123], v[152:155], v[136:139], v[120:123]
  v_mfma_f32_16x16x32_bf16 v[124:127], v[152:155], v[140:143], v[124:127]
  s_waitcnt lgkmcnt(0)
  v_min_u32 v20, v20, v21
  v_cmp_gt_u32 vcc, 9, v20
  s_nop 0
  s_cbranch_vccnz adaLN_cond__sliding_local_dilated__glu_gated_geglu__prompt_kernel_g98
adaLN_cond__sliding_local_dilated__glu_gated_geglu__prompt_kernel_h99:
  v_add_u32 v108, 49152, v108
  ds_read_b64_tr_b16 v[128:129], v108 offset:64
  ds_read_b64_tr_b16 v[130:131], v108 offset:832
  ds_read_b64_tr_b16 v[132:133], v108 offset:96
  ds_read_b64_tr_b16 v[134:135], v108 offset:864
  ds_read_b64_tr_b16 v[136:137], v108 offset:128
  ds_read_b64_tr_b16 v[138:139], v108 offset:896
  ds_read_b64_tr_b16 v[140:141], v108 offset:160
  ds_read_b64_tr_b16 v[142:143], v108 offset:928
  ds_read_b64 v[20:21], v18 offset:8
  s_waitcnt vmcnt(3)
  v_mfma_f32_16x16x32_bf16 v[112:115], v[212:215], v[156:159], v[112:115]
  v_mfma_f32_16x16x32_bf16 v[116:119], v[216:219], v[156:159], v[116:119]
  v_mfma_f32_16x16x32_bf16 v[120:123], v[156:159], v[220:223], v[120:123]
  v_mfma_f32_16x16x32_bf16 v[124:127], v[156:159], v[224:227], v[124:127]
  s_waitcnt lgkmcnt(0)
  v_min_u32 v20, v20, v21
  v_cmp_gt_u32 vcc, 11, v20
  s_nop 0
  s_cbranch_vccnz adaLN_cond__sliding_local_dilated__glu_gated_geglu__prompt_kernel_g100
adaLN_cond__sliding_local_dilated__glu_gated_geglu__prompt_kernel_h101:
  ds_read_b64_tr_b16 v[212:213], v108 offset:12352
  ds_read_b64_tr_b16 v[214:215], v108 offset:13120
  ds_read_b64_tr_b16 v[216:217], v108 offset:12384
  ds_read_b64_tr_b16 v[218:219], v108 offset:13152
  ds_read_b64_tr_b16 v[220:221], v108 offset:12416
  ds_read_b64_tr_b16 v[222:223], v108 offset:13184
  ds_read_b64_tr_b16 v[224:225], v108 offset:12448
  ds_read_b64_tr_b16 v[226:227], v108 offset:13216
  ds_read_b64 v[20:21], v18 offset:8
  s_waitcnt vmcnt(2)
  v_mfma_f32_16x16x32_bf16 v[112:115], v[128:131], v[160:163], v[112:115]
  v_mfma_f32_16x16x32_bf16 v[116:119], v[132:135], v[160:163], v[116:119]
  v_mfma_f32_16x16x32_bf16 v[120:123], v[160:163], v[136:139], v[120:123]
  v_mfma_f32_16x16x32_bf16 v[124:127], v[160:163], v[140:143], v[124:127]
  s_waitcnt lgkmcnt(0)
  v_min_u32 v20, v20, v21
  v_cmp_gt_u32 vcc, 13, v20
  s_nop 0
  s_cbranch_vccnz adaLN_cond__sliding_local_dilated__glu_gated_geglu__prompt_kernel_g102
adaLN_cond__sliding_local_dilated__glu_gated_geglu__prompt_kernel_h103:
  ds_read_b64_tr_b16 v[128:129], v108 offset:24640
  ds_read_b64_tr_b16 v[130:131], v108 offset:25408
  ds_read_b64_tr_b16 v[132:133], v108 offset:24672
  ds_read_b64_tr_b16 v[134:135], v108 offset:25440
  ds_read_b64_tr_b16 v[136:137], v108 offset:24704
  ds_read_b64_tr_b16 v[138:139], v108 offset:25472
  ds_read_b64_tr_b16 v[140:141], v108 offset:24736
  ds_read_b64_tr_b16 v[142:143], v108 offset:25504
  s_waitcnt vmcnt(1)
  v_mfma_f32_16x16x32_bf16 v[112:115], v[212:215], v[164:167], v[112:115]
  v_mfma_f32_16x16x32_bf16 v[116:119], v[216:219], v[164:167], v[116:119]
  v_mfma_f32_16x16x32_bf16 v[120:123], v[164:167], v[220:223], v[120:123]
  v_mfma_f32_16x16x32_bf16 v[124:127], v[164:167], v[224:227], v[124:127]
  s_waitcnt vmcnt(0)
  s_waitcnt lgkmcnt(6)
  v_mfma_f32_16x16x32_bf16 v[112:115], v[128:131], v[168:171], v[112:115]
  s_waitcnt lgkmcnt(4)
  v_mfma_f32_16x16x32_bf16 v[116:119], v[132:135], v[168:171], v[116:119]
  s_waitcnt lgkmcnt(2)
  v_mfma_f32_16x16x32_bf16 v[120:123], v[168:171], v[136:139], v[120:123]
  s_waitcnt lgkmcnt(0)
  v_mfma_f32_16x16x32_bf16 v[124:127], v[168:171], v[140:143], v[124:127]
  s_nop 1
  ds_write_b128 v109, v[112:115] offset:0
  s_nop 0
  ds_write_b128 v109, v[116:119] offset:1024
  s_nop 0
  ds_write_b128 v109, v[120:123] offset:2048
  s_nop 0
  ds_write_b128 v109, v[124:127] offset:3072
  ds_write_b32 v18, v4 offset:4
  s_branch L_hw
L_hv:
  s_waitcnt lgkmcnt(0)
  v_min_u32 v20, v20, v21
  v_cmp_gt_u32 vcc, 2, v20
  s_nop 0
  s_cbranch_vccnz adaLN_cond__sliding_local_dilated__glu_gated_geglu__prompt_kernel_g104
adaLN_cond__sliding_local_dilated__glu_gated_geglu__prompt_kernel_h105:
  ds_read_b64_tr_b16 v[128:129], v108 offset:64
  ds_read_b64_tr_b16 v[130:131], v108 offset:832
  ds_read_b64_tr_b16 v[132:133], v108 offset:96
  ds_read_b64_tr_b16 v[134:135], v108 offset:864
  ds_read_b64_tr_b16 v[136:137], v108 offset:128
  ds_read_b64_tr_b16 v[138:139], v108 offset:896
  ds_read_b64_tr_b16 v[140:141], v108 offset:160
  ds_read_b64_tr_b16 v[142:143], v108 offset:928
  ds_read_b64 v[20:21], v18 offset:8
  s_waitcnt lgkmcnt(0)
  v_min_u32 v20, v20, v21
  v_cmp_gt_u32 vcc, 4, v20
  s_nop 0
  s_cbranch_vccnz adaLN_cond__sliding_local_dilated__glu_gated_geglu__prompt_kernel_g106
adaLN_cond__sliding_local_dilated__glu_gated_geglu__prompt_kernel_h107:
  ds_read_b64_tr_b16 v[212:213], v108 offset:12352
  ds_read_b64_tr_b16 v[214:215], v108 offset:13120
  ds_read_b64_tr_b16 v[216:217], v108 offset:12384
  ds_read_b64_tr_b16 v[218:219], v108 offset:13152
  ds_read_b64_tr_b16 v[220:221], v108 offset:12416
  ds_read_b64_tr_b16 v[222:223], v108 offset:13184
  ds_read_b64_tr_b16 v[224:225], v108 offset:12448
  ds_read_b64_tr_b16 v[226:227], v108 offset:13216
  ds_read_b64 v[20:21], v18 offset:8
  s_waitcnt vmcnt(6)
  v_mfma_f32_16x16x32_bf16 v[112:115], v[128:131], v[144:147], 0
  v_mfma_f32_16x16x32_bf16 v[116:119], v[132:135], v[144:147], 0
  v_mfma_f32_16x16x32_bf16 v[120:123], v[144:147], v[136:139], 0
  v_mfma_f32_16x16x32_bf16 v[124:127], v[144:147], v[140:143], 0
  s_waitcnt lgkmcnt(0)
  v_min_u32 v20, v20, v21
  v_cmp_gt_u32 vcc, 6, v20
  s_nop 0
  s_cbranch_vccnz adaLN_cond__sliding_local_dilated__glu_gated_geglu__prompt_kernel_g108
adaLN_cond__sliding_local_dilated__glu_gated_geglu__prompt_kernel_h109:
  ds_read_b64_tr_b16 v[128:129], v108 offset:24640
  ds_read_b64_tr_b16 v[130:131], v108 offset:25408
  ds_read_b64_tr_b16 v[132:133], v108 offset:24672
  ds_read_b64_tr_b16 v[134:135], v108 offset:25440
  ds_read_b64_tr_b16 v[136:137], v108 offset:24704
  ds_read_b64_tr_b16 v[138:139], v108 offset:25472
  ds_read_b64_tr_b16 v[140:141], v108 offset:24736
  ds_read_b64_tr_b16 v[142:143], v108 offset:25504
  ds_read_b64 v[20:21], v18 offset:8
  s_waitcnt vmcnt(5)
  v_mfma_f32_16x16x32_bf16 v[112:115], v[212:215], v[148:151], v[112:115]
  v_mfma_f32_16x16x32_bf16 v[116:119], v[216:219], v[148:151], v[116:119]
  v_mfma_f32_16x16x32_bf16 v[120:123], v[148:151], v[220:223], v[120:123]
  v_mfma_f32_16x16x32_bf16 v[124:127], v[148:151], v[224:227], v[124:127]
  s_waitcnt lgkmcnt(0)
  v_min_u32 v20, v20, v21
  v_cmp_gt_u32 vcc, 8, v20
  s_nop 0
  s_cbranch_vccnz adaLN_cond__sliding_local_dilated__glu_gated_geglu__prompt_kernel_g110
adaLN_cond__sliding_local_dilated__glu_gated_geglu__prompt_kernel_h111:
  ds_read_b64_tr_b16 v[212:213], v108 offset:36928
  ds_read_b64_tr_b16 v[214:215], v108 offset:37696
  ds_read_b64_tr_b16 v[216:217], v108 offset:36960
  ds_read_b64_tr_b16 v[218:219], v108 offset:37728
  ds_read_b64_tr_b16 v[220:221], v108 offset:36992
  ds_read_b64_tr_b16 v[222:223], v108 offset:37760
  ds_read_b64_tr_b16 v[224:225], v108 offset:37024
  ds_read_b64_tr_b16 v[226:227], v108 offset:37792
  ds_read_b64 v[20:21], v18 offset:8
  s_waitcnt vmcnt(4)
  v_mfma_f32_16x16x32_bf16 v[112:115], v[128:131], v[152:155], v[112:115]
  v_mfma_f32_16x16x32_bf16 v[116:119], v[132:135], v[152:155], v[116:119]
  v_mfma_f32_16x16x32_bf16 v[120:123], v[152:155], v[136:139], v[120:123]
  v_mfma_f32_16x16x32_bf16 v[124:127], v[152:155], v[140:143], v[124:127]
  s_waitcnt lgkmcnt(0)
  v_min_u32 v20, v20, v21
  v_cmp_gt_u32 vcc, 10, v20
  s_nop 0
  s_cbranch_vccnz adaLN_cond__sliding_local_dilated__glu_gated_geglu__prompt_kernel_g112
adaLN_cond__sliding_local_dilated__glu_gated_geglu__prompt_kernel_h113:
  v_add_u32 v108, 49152, v108
  ds_read_b64_tr_b16 v[128:129], v108 offset:64
  ds_read_b64_tr_b16 v[130:131], v108 offset:832
  ds_read_b64_tr_b16 v[132:133], v108 offset:96
  ds_read_b64_tr_b16 v[134:135], v108 offset:864
  ds_read_b64_tr_b16 v[136:137], v108 offset:128
  ds_read_b64_tr_b16 v[138:139], v108 offset:896
  ds_read_b64_tr_b16 v[140:141], v108 offset:160
  ds_read_b64_tr_b16 v[142:143], v108 offset:928
  ds_read_b64 v[20:21], v18 offset:8
  s_waitcnt vmcnt(3)
  v_mfma_f32_16x16x32_bf16 v[112:115], v[212:215], v[156:159], v[112:115]
  v_mfma_f32_16x16x32_bf16 v[116:119], v[216:219], v[156:159], v[116:119]
  v_mfma_f32_16x16x32_bf16 v[120:123], v[156:159], v[220:223], v[120:123]
  v_mfma_f32_16x16x32_bf16 v[124:127], v[156:159], v[224:227], v[124:127]
  s_waitcnt lgkmcnt(0)
  v_min_u32 v20, v20, v21
  v_cmp_gt_u32 vcc, 12, v20
  s_nop 0
  s_cbranch_vccnz adaLN_cond__sliding_local_dilated__glu_gated_geglu__prompt_kernel_g114
adaLN_cond__sliding_local_dilated__glu_gated_geglu__prompt_kernel_h115:
  ds_read_b64_tr_b16 v[212:213], v108 offset:12352
  ds_read_b64_tr_b16 v[214:215], v108 offset:13120
  ds_read_b64_tr_b16 v[216:217], v108 offset:12384
  ds_read_b64_tr_b16 v[218:219], v108 offset:13152
  ds_read_b64_tr_b16 v[220:221], v108 offset:12416
  ds_read_b64_tr_b16 v[222:223], v108 offset:13184
  ds_read_b64_tr_b16 v[224:225], v108 offset:12448
  ds_read_b64_tr_b16 v[226:227], v108 offset:13216
  ds_read_b64 v[20:21], v18 offset:8
  s_waitcnt vmcnt(2)
  v_mfma_f32_16x16x32_bf16 v[112:115], v[128:131], v[160:163], v[112:115]
  v_mfma_f32_16x16x32_bf16 v[116:119], v[132:135], v[160:163], v[116:119]
  v_mfma_f32_16x16x32_bf16 v[120:123], v[160:163], v[136:139], v[120:123]
  v_mfma_f32_16x16x32_bf16 v[124:127], v[160:163], v[140:143], v[124:127]
  s_waitcnt lgkmcnt(0)
  v_min_u32 v20, v20, v21
  v_cmp_gt_u32 vcc, 14, v20
  s_nop 0
  s_cbranch_vccnz adaLN_cond__sliding_local_dilated__glu_gated_geglu__prompt_kernel_g116
adaLN_cond__sliding_local_dilated__glu_gated_geglu__prompt_kernel_h117:
  ds_read_b64_tr_b16 v[128:129], v108 offset:24640
  ds_read_b64_tr_b16 v[130:131], v108 offset:25408
  ds_read_b64_tr_b16 v[132:133], v108 offset:24672
  ds_read_b64_tr_b16 v[134:135], v108 offset:25440
  ds_read_b64_tr_b16 v[136:137], v108 offset:24704
  ds_read_b64_tr_b16 v[138:139], v108 offset:25472
  ds_read_b64_tr_b16 v[140:141], v108 offset:24736
  ds_read_b64_tr_b16 v[142:143], v108 offset:25504
  s_waitcnt vmcnt(1)
  v_mfma_f32_16x16x32_bf16 v[112:115], v[212:215], v[164:167], v[112:115]
  v_mfma_f32_16x16x32_bf16 v[116:119], v[216:219], v[164:167], v[116:119]
  v_mfma_f32_16x16x32_bf16 v[120:123], v[164:167], v[220:223], v[120:123]
  v_mfma_f32_16x16x32_bf16 v[124:127], v[164:167], v[224:227], v[124:127]
  s_waitcnt vmcnt(0)
  s_waitcnt lgkmcnt(6)
  v_mfma_f32_16x16x32_bf16 v[112:115], v[128:131], v[168:171], v[112:115]
  s_waitcnt lgkmcnt(4)
  v_mfma_f32_16x16x32_bf16 v[116:119], v[132:135], v[168:171], v[116:119]
  s_waitcnt lgkmcnt(2)
  v_mfma_f32_16x16x32_bf16 v[120:123], v[168:171], v[136:139], v[120:123]
  s_waitcnt lgkmcnt(0)
  v_mfma_f32_16x16x32_bf16 v[124:127], v[168:171], v[140:143], v[124:127]
  s_mov_b32 s99, 1048576
adaLN_cond__sliding_local_dilated__glu_gated_geglu__prompt_kernel_p118:
  ds_read_b32 v8, v18 offset:4
  s_waitcnt lgkmcnt(0)
  v_cmp_gt_u32 vcc, 1, v8
  s_sub_u32 s99, s99, 1
  s_cbranch_scc1 adaLN_cond__sliding_local_dilated__glu_gated_geglu__prompt_kernel_d119
  s_cbranch_vccnz adaLN_cond__sliding_local_dilated__glu_gated_geglu__prompt_kernel_p118
adaLN_cond__sliding_local_dilated__glu_gated_geglu__prompt_kernel_d119:
  ds_read_b128 v[176:179], v109 offset:0
  ds_read_b128 v[180:183], v109 offset:1024
  ds_read_b128 v[184:187], v109 offset:2048
  ds_read_b128 v[188:191], v109 offset:3072
  v_lshlrev_b32 v110, 9, v16
  v_lshl_add_u32 v110, v14, 4, v110
  v_lshl_add_u32 v110, v9, 3, v110
  v_add_u32 v110, 65536, v110
  v_add_u32 v108, 65536, v2
  s_waitcnt lgkmcnt(3)
  v_add_f32 v112, v112, v176
  v_add_f32 v113, v113, v177
  v_add_f32 v114, v114, v178
  v_add_f32 v115, v115, v179
  s_waitcnt lgkmcnt(2)
  v_add_f32 v116, v116, v180
  v_add_f32 v117, v117, v181
  v_add_f32 v118, v118, v182
  v_add_f32 v119, v119, v183
  s_waitcnt lgkmcnt(1)
  v_add_f32 v120, v120, v184
  v_add_f32 v121, v121, v185
  v_add_f32 v122, v122, v186
  v_add_f32 v123, v123, v187
  s_waitcnt lgkmcnt(0)
  v_add_f32 v124, v124, v188
  v_add_f32 v125, v125, v189
  v_add_f32 v126, v126, v190
  v_add_f32 v127, v127, v191
  v_cvt_pk_bf16_f32 v112, v112, v113
  v_cvt_pk_bf16_f32 v113, v114, v115
  v_cvt_pk_bf16_f32 v116, v116, v117
  v_cvt_pk_bf16_f32 v117, v118, v119
  v_cvt_pk_bf16_f32 v120, v120, v121
  v_cvt_pk_bf16_f32 v121, v122, v123
  v_cvt_pk_bf16_f32 v124, v124, v125
  v_cvt_pk_bf16_f32 v125, v126, v127
  ds_write_b64 v110, v[112:113] offset:0
  ds_write_b64 v108, v[120:121] offset:1024
  ds_write_b64 v110, v[116:117] offset:256
  ds_write_b64 v108, v[124:125] offset:1032
L_hw:
  s_sub_u32 s88, s50, 16
  s_cmp_ge_u32 s88, 14
  s_cbranch_scc1 adaLN_cond__sliding_local_dilated__glu_gated_geglu__prompt_kernel_ep120
  v_lshrrev_b32 v12, 3, v1
  v_mul_u32_u24 v12, 896, v12
  v_and_b32 v13, 7, v1
  v_lshl_add_u32 v12, v13, 4, v12
  s_lshl_b32 s88, s82, 7
  s_add_u32 s88, s88, 331264
  buffer_load_dwordx4 v[100:103], v12, s[44:47], s88 offen sc1
adaLN_cond__sliding_local_dilated__glu_gated_geglu__prompt_kernel_ep120:
  s_waitcnt lgkmcnt(0)
L_ha:
  s_setprio 0
  s_barrier
  s_cmp_ge_u32 s50, 16
  s_cbranch_scc1 L_p2c
  s_barrier
  s_branch L_free
L_p2c:
  s_cmp_ge_u32 s50, 30
  s_cbranch_scc1 L_sp0
  s_and_b32 s88, s52, 3
  s_mul_i32 s94, s88, 7168
  s_lshl_b32 s95, s88, 10
  s_add_u32 m0, s95, 106496
  s_add_u32 s88, s94, 0
  buffer_load_dwordx4 v104, s[12:15], s88 offen lds
  s_add_u32 m0, s95, 110592
  s_add_u32 s88, s94, 28672
  buffer_load_dwordx4 v104, s[12:15], s88 offen lds
  s_add_u32 m0, s95, 114688
  s_add_u32 s88, s94, 57344
  buffer_load_dwordx4 v104, s[12:15], s88 offen lds
  s_add_u32 m0, s95, 118784
  s_add_u32 s88, s94, 86016
  buffer_load_dwordx4 v104, s[12:15], s88 offen lds
  s_add_u32 m0, s95, 122880
  s_add_u32 s88, s94, 114688
  buffer_load_dwordx4 v104, s[12:15], s88 offen lds
  s_add_u32 m0, s95, 126976
  s_add_u32 s88, s94, 143360
  buffer_load_dwordx4 v104, s[12:15], s88 offen lds
  s_add_u32 m0, s95, 131072
  s_add_u32 s88, s94, 172032
  buffer_load_dwordx4 v104, s[12:15], s88 offen lds
  s_add_u32 m0, s95, 135168
  s_add_u32 s88, s94, 200704
  buffer_load_dwordx4 v104, s[12:15], s88 offen lds
  s_add_u32 m0, s95, 139264
  s_add_u32 s88, s94, 229376
  buffer_load_dwordx4 v104, s[12:15], s88 offen lds
  s_add_u32 m0, s95, 143360
  s_add_u32 s88, s94, 258048
  buffer_load_dwordx4 v104, s[12:15], s88 offen lds
  s_add_u32 m0, s95, 147456
  s_add_u32 s88, s94, 286720
  buffer_load_dwordx4 v104, s[12:15], s88 offen lds
  s_add_u32 m0, s95, 151552
  s_add_u32 s88, s94, 315392
  buffer_load_dwordx4 v104, s[12:15], s88 offen lds
  s_add_u32 m0, s95, 155648
  s_add_u32 s88, s94, 344064
  buffer_load_dwordx4 v104, s[12:15], s88 offen lds
  s_add_u32 m0, s95, 159744
  s_add_u32 s88, s94, 372736
  buffer_load_dwordx4 v104, s[12:15], s88 offen lds
  s_lshl_b32 s92, s53, 3
  s_add_u32 s92, s92, s83
  s_mul_i32 s93, s92, 28672
  s_and_b32 s90, s52, 3
  s_mul_i32 s90, s90, 4608
  s_add_u32 s90, s90, 79872
  v_lshrrev_b32 v14, 3, v1
  v_mul_u32_u24 v14, 144, v14
  v_and_b32 v15, 7, v1
  v_lshl_add_u32 v14, v15, 4, v14
  v_add_u32 v14, s90, v14
  ds_write_b128 v14, v[84:87] offset:0
  ds_write_b128 v14, v[88:91] offset:1152
  ds_write_b128 v14, v[92:95] offset:2304
  ds_write_b128 v14, v[96:99] offset:3456
  s_waitcnt lgkmcnt(0)
  v_and_b32 v15, 31, v1
  v_mul_u32_u24 v14, 144, v15
  v_lshl_add_u32 v14, v9, 3, v14
  v_add_u32 v14, s90, v14
  v_lshlrev_b32 v15, 3, v15
  ds_read_b64 v[200:201], v14 offset:0
  ds_read_b64 v[202:203], v14 offset:16
  ds_read_b64 v[204:205], v14 offset:32
  ds_read_b64 v[206:207], v14 offset:48
  ds_read_b64 v[208:209], v14 offset:64
  ds_read_b64 v[210:211], v14 offset:80
  ds_read_b64 v[212:213], v14 offset:96
  ds_read_b64 v[214:215], v14 offset:112
  s_lshl_b32 s88, s83, 6
  s_add_u32 s88, s88, s56
  s_add_u32 s88, s88, 1536
  s_add_u32 s93, s93, 2490368
  s_lshl_b32 s89, s82, 12
  s_add_u32 s97, s93, s89
  s_lshl_b32 s91, s83, 11
  s_add_u32 s91, s91, s56
  s_add_u32 s91, s91, 8192
  s_lshl_b32 s90, s82, 8
  s_add_u32 s90, s90, s91
  s_add_u32 s95, s83, 1
  s_cmp_eq_u32 s95, 4
  s_cselect_b32 s95, 0, s95
  s_mul_i32 s95, s95, 28672
  s_add_u32 s95, s95, s89
  s_add_u32 s95, s95, s61
  s_lshl_b32 s94, s83, 7
  s_lshl_b32 s89, s82, 2
  s_add_u32 s94, s94, s89
  s_add_u32 s94, s94, s56
  s_add_u32 s94, s94, 2048
  s_mov_b64 exec, 0xffff
  buffer_load_dword v255, v17, s[44:47], s91 offen
  s_mov_b64 exec, 1
  buffer_load_dword v255, off, s[44:47], s94
  s_mov_b64 exec, -1
  s_mov_b32 s85, s88
  s_waitcnt vmcnt(16)
  s_mov_b32 s99, 262144
  s_and_b32 s89, s52, 3
  s_lshl_b32 s89, s89, 10
  s_add_u32 s89, s89, 98304
adaLN_cond__sliding_local_dilated__glu_gated_geglu__prompt_kernel_c123:
  v_xor_b32 v8, s2, v100
  v_xor_b32 v3, s2, v101
  v_bitop3_b32 v8, v8, v102, s2 bitop3:0xf6
  v_bitop3_b32 v3, v3, v103, s2 bitop3:0xf6
  v_or_b32 v8, v8, v3
  v_and_b32 v8, 0xffff, v8
  v_cmp_ne_u32 vcc, 0, v8
  s_nop 0
  s_cbranch_vccnz adaLN_cond__sliding_local_dilated__glu_gated_geglu__prompt_kernel_p121
adaLN_cond__sliding_local_dilated__glu_gated_geglu__prompt_kernel_d122:
  v_and_b32 v100, 0xffff0000, v100
  v_and_b32 v101, 0xffff0000, v101
  v_and_b32 v102, 0xffff0000, v102
  v_and_b32 v103, 0xffff0000, v103
  v_add_u32 v13, s89, v2
  ds_write_b128 v13, v[100:103]
  v_lshlrev_b32 v39, 7, v9
  v_add_u32 v39, s89, v39
  s_mov_b32 s88, s85
  s_waitcnt vmcnt(0)
  s_mov_b64 exec, 1
  ds_add_u32 v18, v4 offset:44
  s_mov_b64 exec, -1
  s_mov_b32 s99, 1048576
  s_waitcnt lgkmcnt(0)
adaLN_cond__sliding_local_dilated__glu_gated_geglu__prompt_kernel_p124:
  ds_read_b32 v8, v18 offset:44
  s_waitcnt lgkmcnt(0)
  v_cmp_gt_u32 vcc, 4, v8
  s_sub_u32 s99, s99, 1
  s_cbranch_scc1 adaLN_cond__sliding_local_dilated__glu_gated_geglu__prompt_kernel_d125
  s_cbranch_vccnz adaLN_cond__sliding_local_dilated__glu_gated_geglu__prompt_kernel_p124
adaLN_cond__sliding_local_dilated__glu_gated_geglu__prompt_kernel_d125:
  ds_read_b64_tr_b16 v[40:41], v37 offset:0
  ds_read_b64_tr_b16 v[42:43], v37 offset:512
  ds_read_b64_tr_b16 v[44:45], v38 offset:0
  ds_read_b64_tr_b16 v[46:47], v38 offset:512
  ds_read_b64_tr_b16 v[48:49], v37 offset:2048
  ds_read_b64_tr_b16 v[50:51], v37 offset:2560
  ds_read_b64_tr_b16 v[52:53], v38 offset:2048
  ds_read_b64_tr_b16 v[54:55], v38 offset:2560
  ds_read_b64_tr_b16 v[56:57], v37 offset:4096
  ds_read_b64_tr_b16 v[58:59], v37 offset:4608
  ds_read_b64_tr_b16 v[60:61], v38 offset:4096
  ds_read_b64_tr_b16 v[62:63], v38 offset:4608
  v_min_u32 v3, 15, v1
  v_lshlrev_b32 v3, 2, v3
  s_mov_b32 s99, 262144
adaLN_cond__sliding_local_dilated__glu_gated_geglu__prompt_kernel_p126:
  buffer_load_dword v8, v3, s[44:47], s88 offen sc1
  s_waitcnt vmcnt(0)
  v_cmp_ne_u32 vcc, 1, v8
  s_sub_u32 s99, s99, 1
  s_cbranch_scc1 adaLN_cond__sliding_local_dilated__glu_gated_geglu__prompt_kernel_d127
  s_cbranch_vccnz adaLN_cond__sliding_local_dilated__glu_gated_geglu__prompt_kernel_p126
adaLN_cond__sliding_local_dilated__glu_gated_geglu__prompt_kernel_d127:
  buffer_load_dwordx4 v[104:107], v2, s[44:47], s93 offen offset:0 sc1
  buffer_load_dwordx4 v[108:111], v2, s[44:47], s93 offen offset:1024 sc1
  buffer_load_dwordx4 v[112:115], v2, s[44:47], s93 offen offset:2048 sc1
  buffer_load_dwordx4 v[116:119], v2, s[44:47], s93 offen offset:3072 sc1
  s_add_u32 s93, s93, 4096
  buffer_load_dwordx4 v[120:123], v2, s[44:47], s93 offen offset:0 sc1
  buffer_load_dwordx4 v[124:127], v2, s[44:47], s93 offen offset:1024 sc1
  buffer_load_dwordx4 v[128:131], v2, s[44:47], s93 offen offset:2048 sc1
  buffer_load_dwordx4 v[132:135], v2, s[44:47], s93 offen offset:3072 sc1
  s_add_u32 s93, s93, 4096
  buffer_load_dwordx4 v[136:139], v2, s[44:47], s93 offen offset:0 sc1
  buffer_load_dwordx4 v[140:143], v2, s[44:47], s93 offen offset:1024 sc1
  s_waitcnt vmcnt(9)
  s_waitcnt lgkmcnt(10)
  v_mfma_f32_32x32x16_bf16 v[72:87], v[40:43], v[104:107], 0
  ds_read_b64_tr_b16 v[64:65], v37 offset:6144
  ds_read_b64_tr_b16 v[66:67], v37 offset:6656
  buffer_load_dwordx4 v[144:147], v2, s[44:47], s93 offen offset:2048 sc1
  s_waitcnt lgkmcnt(10)
  v_mfma_f32_32x32x16_bf16 v[88:103], v[44:47], v[104:107], 0
  ds_read_b64_tr_b16 v[68:69], v38 offset:6144
  ds_read_b64_tr_b16 v[70:71], v38 offset:6656
  s_waitcnt vmcnt(9)
  s_waitcnt lgkmcnt(10)
  v_mfma_f32_32x32x16_bf16 v[72:87], v[48:51], v[108:111], v[72:87]
  ds_read_b64_tr_b16 v[40:41], v37 offset:8192
  ds_read_b64_tr_b16 v[42:43], v37 offset:8704
  buffer_load_dwordx4 v[148:151], v2, s[44:47], s93 offen offset:3072 sc1
  s_waitcnt lgkmcnt(10)
  v_mfma_f32_32x32x16_bf16 v[88:103], v[52:55], v[108:111], v[88:103]
  ds_read_b64_tr_b16 v[44:45], v38 offset:8192
  ds_read_b64_tr_b16 v[46:47], v38 offset:8704
  s_waitcnt vmcnt(9)
  s_waitcnt lgkmcnt(10)
  v_mfma_f32_32x32x16_bf16 v[72:87], v[56:59], v[112:115], v[72:87]
  ds_read_b64_tr_b16 v[48:49], v37 offset:10240
  ds_read_b64_tr_b16 v[50:51], v37 offset:10752
  s_add_u32 s93, s93, 4096
  buffer_load_dwordx4 v[152:155], v2, s[44:47], s93 offen offset:0 sc1
  s_waitcnt lgkmcnt(10)
  v_mfma_f32_32x32x16_bf16 v[88:103], v[60:63], v[112:115], v[88:103]
  ds_read_b64_tr_b16 v[52:53], v38 offset:10240
  ds_read_b64_tr_b16 v[54:55], v38 offset:10752
  s_waitcnt vmcnt(9)
  s_waitcnt lgkmcnt(10)
  v_mfma_f32_32x32x16_bf16 v[72:87], v[64:67], v[116:119], v[72:87]
  ds_read_b64_tr_b16 v[56:57], v37 offset:12288
  ds_read_b64_tr_b16 v[58:59], v37 offset:12800
  buffer_load_dwordx4 v[156:159], v2, s[44:47], s93 offen offset:1024 sc1
  s_waitcnt lgkmcnt(10)
  v_mfma_f32_32x32x16_bf16 v[88:103], v[68:71], v[116:119], v[88:103]
  ds_read_b64_tr_b16 v[60:61], v38 offset:12288
  ds_read_b64_tr_b16 v[62:63], v38 offset:12800
  s_waitcnt vmcnt(9)
  s_waitcnt lgkmcnt(10)
  v_mfma_f32_32x32x16_bf16 v[72:87], v[40:43], v[120:123], v[72:87]
  ds_read_b64_tr_b16 v[64:65], v37 offset:14336
  ds_read_b64_tr_b16 v[66:67], v37 offset:14848
  buffer_load_dwordx4 v[160:163], v2, s[44:47], s93 offen offset:2048 sc1
  s_waitcnt lgkmcnt(10)
  v_mfma_f32_32x32x16_bf16 v[88:103], v[44:47], v[120:123], v[88:103]
  ds_read_b64_tr_b16 v[68:69], v38 offset:14336
  ds_read_b64_tr_b16 v[70:71], v38 offset:14848
  v_lshlrev_b32 v216, 16, v200
  v_and_b32 v217, 0xffff0000, v200
  s_waitcnt vmcnt(9)
  s_waitcnt lgkmcnt(10)
  v_mfma_f32_32x32x16_bf16 v[72:87], v[48:51], v[124:127], v[72:87]
  ds_read_b64_tr_b16 v[40:41], v37 offset:16384
  ds_read_b64_tr_b16 v[42:43], v37 offset:16896
  buffer_load_dwordx4 v[164:167], v2, s[44:47], s93 offen offset:3072 sc1
  s_waitcnt lgkmcnt(10)
  v_mfma_f32_32x32x16_bf16 v[88:103], v[52:55], v[124:127], v[88:103]
  ds_read_b64_tr_b16 v[44:45], v38 offset:16384
  ds_read_b64_tr_b16 v[46:47], v38 offset:16896
  v_lshlrev_b32 v218, 16, v201
  v_and_b32 v219, 0xffff0000, v201
  s_waitcnt vmcnt(9)
  s_waitcnt lgkmcnt(10)
  v_mfma_f32_32x32x16_bf16 v[72:87], v[56:59], v[128:131], v[72:87]
  ds_read_b64_tr_b16 v[48:49], v37 offset:18432
  ds_read_b64_tr_b16 v[50:51], v37 offset:18944
  s_add_u32 s93, s93, 4096
  buffer_load_dwordx4 v[104:107], v2, s[44:47], s93 offen offset:0 sc1
  s_waitcnt lgkmcnt(10)
  v_mfma_f32_32x32x16_bf16 v[88:103], v[60:63], v[128:131], v[88:103]
  ds_read_b64_tr_b16 v[52:53], v38 offset:18432
  ds_read_b64_tr_b16 v[54:55], v38 offset:18944
  v_lshlrev_b32 v220, 16, v202
  v_and_b32 v221, 0xffff0000, v202
  s_waitcnt vmcnt(9)
  s_waitcnt lgkmcnt(10)
  v_mfma_f32_32x32x16_bf16 v[72:87], v[64:67], v[132:135], v[72:87]
  ds_read_b64_tr_b16 v[56:57], v37 offset:20480
  ds_read_b64_tr_b16 v[58:59], v37 offset:20992
  buffer_load_dwordx4 v[108:111], v2, s[44:47], s93 offen offset:1024 sc1
  s_waitcnt lgkmcnt(10)
  v_mfma_f32_32x32x16_bf16 v[88:103], v[68:71], v[132:135], v[88:103]
  ds_read_b64_tr_b16 v[60:61], v38 offset:20480
  ds_read_b64_tr_b16 v[62:63], v38 offset:20992
  v_lshlrev_b32 v222, 16, v203
  v_and_b32 v223, 0xffff0000, v203
  s_waitcnt vmcnt(9)
  s_waitcnt lgkmcnt(10)
  v_mfma_f32_32x32x16_bf16 v[72:87], v[40:43], v[136:139], v[72:87]
  ds_read_b64_tr_b16 v[64:65], v37 offset:22528
  ds_read_b64_tr_b16 v[66:67], v37 offset:23040
  buffer_load_dwordx4 v[112:115], v2, s[44:47], s93 offen offset:2048 sc1
  s_waitcnt lgkmcnt(10)
  v_mfma_f32_32x32x16_bf16 v[88:103], v[44:47], v[136:139], v[88:103]
  ds_read_b64_tr_b16 v[68:69], v38 offset:22528
  ds_read_b64_tr_b16 v[70:71], v38 offset:23040
  v_lshlrev_b32 v224, 16, v204
  v_and_b32 v225, 0xffff0000, v204
  s_waitcnt vmcnt(9)
  s_waitcnt lgkmcnt(10)
  v_mfma_f32_32x32x16_bf16 v[72:87], v[48:51], v[140:143], v[72:87]
  ds_read_b64_tr_b16 v[40:41], v37 offset:24576
  ds_read_b64_tr_b16 v[42:43], v37 offset:25088
  buffer_load_dwordx4 v[116:119], v2, s[44:47], s93 offen offset:3072 sc1
  s_waitcnt lgkmcnt(10)
  v_mfma_f32_32x32x16_bf16 v[88:103], v[52:55], v[140:143], v[88:103]
  ds_read_b64_tr_b16 v[44:45], v38 offset:24576
  ds_read_b64_tr_b16 v[46:47], v38 offset:25088
  v_lshlrev_b32 v226, 16, v205
  v_and_b32 v227, 0xffff0000, v205
  s_waitcnt vmcnt(9)
  s_waitcnt lgkmcnt(10)
  v_mfma_f32_32x32x16_bf16 v[72:87], v[56:59], v[144:147], v[72:87]
  ds_read_b64_tr_b16 v[48:49], v37 offset:26624
  ds_read_b64_tr_b16 v[50:51], v37 offset:27136
  s_add_u32 s93, s93, 4096
  buffer_load_dwordx4 v[120:123], v2, s[44:47], s93 offen offset:0 sc1
  s_waitcnt lgkmcnt(10)
  v_mfma_f32_32x32x16_bf16 v[88:103], v[60:63], v[144:147], v[88:103]
  ds_read_b64_tr_b16 v[52:53], v38 offset:26624
  ds_read_b64_tr_b16 v[54:55], v38 offset:27136
  v_lshlrev_b32 v228, 16, v206
  v_and_b32 v229, 0xffff0000, v206
  s_waitcnt vmcnt(9)
  s_waitcnt lgkmcnt(10)
  v_mfma_f32_32x32x16_bf16 v[72:87], v[64:67], v[148:151], v[72:87]
  ds_read_b64_tr_b16 v[56:57], v37 offset:28672
  ds_read_b64_tr_b16 v[58:59], v37 offset:29184
  buffer_load_dwordx4 v[124:127], v2, s[44:47], s93 offen offset:1024 sc1
  s_waitcnt lgkmcnt(10)
  v_mfma_f32_32x32x16_bf16 v[88:103], v[68:71], v[148:151], v[88:103]
  ds_read_b64_tr_b16 v[60:61], v38 offset:28672
  ds_read_b64_tr_b16 v[62:63], v38 offset:29184
  v_lshlrev_b32 v230, 16, v207
  v_and_b32 v231, 0xffff0000, v207
  s_waitcnt vmcnt(9)
  s_waitcnt lgkmcnt(10)
  v_mfma_f32_32x32x16_bf16 v[72:87], v[40:43], v[152:155], v[72:87]
  ds_read_b64_tr_b16 v[64:65], v37 offset:30720
  ds_read_b64_tr_b16 v[66:67], v37 offset:31232
  buffer_load_dwordx4 v[128:131], v2, s[44:47], s93 offen offset:2048 sc1
  s_waitcnt lgkmcnt(10)
  v_mfma_f32_32x32x16_bf16 v[88:103], v[44:47], v[152:155], v[88:103]
  ds_read_b64_tr_b16 v[68:69], v38 offset:30720
  ds_read_b64_tr_b16 v[70:71], v38 offset:31232
  v_lshlrev_b32 v232, 16, v208
  v_and_b32 v233, 0xffff0000, v208
  s_waitcnt vmcnt(9)
  s_waitcnt lgkmcnt(10)
  v_mfma_f32_32x32x16_bf16 v[72:87], v[48:51], v[156:159], v[72:87]
  ds_read_b64_tr_b16 v[40:41], v37 offset:32768
  ds_read_b64_tr_b16 v[42:43], v37 offset:33280
  buffer_load_dwordx4 v[132:135], v2, s[44:47], s93 offen offset:3072 sc1
  s_waitcnt lgkmcnt(10)
  v_mfma_f32_32x32x16_bf16 v[88:103], v[52:55], v[156:159], v[88:103]
  ds_read_b64_tr_b16 v[44:45], v38 offset:32768
  ds_read_b64_tr_b16 v[46:47], v38 offset:33280
  v_lshlrev_b32 v234, 16, v209
  v_and_b32 v235, 0xffff0000, v209
  s_waitcnt vmcnt(9)
  s_waitcnt lgkmcnt(10)
  v_mfma_f32_32x32x16_bf16 v[72:87], v[56:59], v[160:163], v[72:87]
  ds_read_b64_tr_b16 v[48:49], v37 offset:34816
  ds_read_b64_tr_b16 v[50:51], v37 offset:35328
  s_add_u32 s93, s93, 4096
  buffer_load_dwordx4 v[136:139], v2, s[44:47], s93 offen offset:0 sc1
  s_waitcnt lgkmcnt(10)
  v_mfma_f32_32x32x16_bf16 v[88:103], v[60:63], v[160:163], v[88:103]
  ds_read_b64_tr_b16 v[52:53], v38 offset:34816
  ds_read_b64_tr_b16 v[54:55], v38 offset:35328
  v_lshlrev_b32 v236, 16, v210
  v_and_b32 v237, 0xffff0000, v210
  s_waitcnt vmcnt(9)
  s_waitcnt lgkmcnt(10)
  v_mfma_f32_32x32x16_bf16 v[72:87], v[64:67], v[164:167], v[72:87]
  ds_read_b64_tr_b16 v[56:57], v37 offset:36864
  ds_read_b64_tr_b16 v[58:59], v37 offset:37376
  buffer_load_dwordx4 v[140:143], v2, s[44:47], s93 offen offset:1024 sc1
  s_waitcnt lgkmcnt(10)
  v_mfma_f32_32x32x16_bf16 v[88:103], v[68:71], v[164:167], v[88:103]
  ds_read_b64_tr_b16 v[60:61], v38 offset:36864
  ds_read_b64_tr_b16 v[62:63], v38 offset:37376
  v_lshlrev_b32 v238, 16, v211
  v_and_b32 v239, 0xffff0000, v211
  s_waitcnt vmcnt(9)
  s_waitcnt lgkmcnt(10)
  v_mfma_f32_32x32x16_bf16 v[72:87], v[40:43], v[104:107], v[72:87]
  ds_read_b64_tr_b16 v[64:65], v37 offset:38912
  ds_read_b64_tr_b16 v[66:67], v37 offset:39424
  buffer_load_dwordx4 v[144:147], v2, s[44:47], s93 offen offset:2048 sc1
  s_waitcnt lgkmcnt(10)
  v_mfma_f32_32x32x16_bf16 v[88:103], v[44:47], v[104:107], v[88:103]
  ds_read_b64_tr_b16 v[68:69], v38 offset:38912
  ds_read_b64_tr_b16 v[70:71], v38 offset:39424
  v_lshlrev_b32 v240, 16, v212
  v_and_b32 v241, 0xffff0000, v212
  s_waitcnt vmcnt(9)
  s_waitcnt lgkmcnt(10)
  v_mfma_f32_32x32x16_bf16 v[72:87], v[48:51], v[108:111], v[72:87]
  ds_read_b64_tr_b16 v[40:41], v37 offset:40960
  ds_read_b64_tr_b16 v[42:43], v37 offset:41472
  buffer_load_dwordx4 v[148:151], v2, s[44:47], s93 offen offset:3072 sc1
  s_waitcnt lgkmcnt(10)
  v_mfma_f32_32x32x16_bf16 v[88:103], v[52:55], v[108:111], v[88:103]
  ds_read_b64_tr_b16 v[44:45], v38 offset:40960
  ds_read_b64_tr_b16 v[46:47], v38 offset:41472
  v_lshlrev_b32 v242, 16, v213
  v_and_b32 v243, 0xffff0000, v213
  s_waitcnt vmcnt(9)
  s_waitcnt lgkmcnt(10)
  v_mfma_f32_32x32x16_bf16 v[72:87], v[56:59], v[112:115], v[72:87]
  ds_read_b64_tr_b16 v[48:49], v37 offset:43008
  ds_read_b64_tr_b16 v[50:51], v37 offset:43520
  s_waitcnt lgkmcnt(10)
  v_mfma_f32_32x32x16_bf16 v[88:103], v[60:63], v[112:115], v[88:103]
  ds_read_b64_tr_b16 v[52:53], v38 offset:43008
  ds_read_b64_tr_b16 v[54:55], v38 offset:43520
  v_lshlrev_b32 v244, 16, v214
  v_and_b32 v245, 0xffff0000, v214
  ds_read_b128 v[168:171], v39 offset:0
  s_waitcnt vmcnt(8)
  s_waitcnt lgkmcnt(11)
  v_mfma_f32_32x32x16_bf16 v[72:87], v[64:67], v[116:119], v[72:87]
  ds_read_b64_tr_b16 v[56:57], v37 offset:45056
  ds_read_b64_tr_b16 v[58:59], v37 offset:45568
  s_waitcnt lgkmcnt(11)
  v_mfma_f32_32x32x16_bf16 v[88:103], v[68:71], v[116:119], v[88:103]
  ds_read_b64_tr_b16 v[60:61], v38 offset:45056
  ds_read_b64_tr_b16 v[62:63], v38 offset:45568
  v_lshlrev_b32 v246, 16, v215
  v_and_b32 v247, 0xffff0000, v215
  ds_read_b128 v[172:175], v39 offset:16
  s_waitcnt vmcnt(7)
  s_waitcnt lgkmcnt(12)
  v_mfma_f32_32x32x16_bf16 v[72:87], v[40:43], v[120:123], v[72:87]
  ds_read_b64_tr_b16 v[64:65], v37 offset:47104
  ds_read_b64_tr_b16 v[66:67], v37 offset:47616
  s_waitcnt lgkmcnt(12)
  v_mfma_f32_32x32x16_bf16 v[88:103], v[44:47], v[120:123], v[88:103]
  ds_read_b64_tr_b16 v[68:69], v38 offset:47104
  ds_read_b64_tr_b16 v[70:71], v38 offset:47616
  ds_read_b128 v[176:179], v39 offset:32
  s_waitcnt vmcnt(6)
  s_waitcnt lgkmcnt(13)
  v_mfma_f32_32x32x16_bf16 v[72:87], v[48:51], v[124:127], v[72:87]
  ds_read_b64_tr_b16 v[40:41], v37 offset:49152
  ds_read_b64_tr_b16 v[42:43], v37 offset:49664
  s_waitcnt lgkmcnt(13)
  v_mfma_f32_32x32x16_bf16 v[88:103], v[52:55], v[124:127], v[88:103]
  ds_read_b64_tr_b16 v[44:45], v38 offset:49152
  ds_read_b64_tr_b16 v[46:47], v38 offset:49664
  ds_read_b128 v[180:183], v39 offset:48
  s_waitcnt vmcnt(5)
  s_waitcnt lgkmcnt(13)
  v_mfma_f32_32x32x16_bf16 v[72:87], v[56:59], v[128:131], v[72:87]
  ds_read_b64_tr_b16 v[48:49], v37 offset:51200
  ds_read_b64_tr_b16 v[50:51], v37 offset:51712
  s_waitcnt lgkmcnt(13)
  v_mfma_f32_32x32x16_bf16 v[88:103], v[60:63], v[128:131], v[88:103]
  ds_read_b64_tr_b16 v[52:53], v38 offset:51200
  ds_read_b64_tr_b16 v[54:55], v38 offset:51712
  ds_read_b128 v[184:187], v39 offset:64
  s_waitcnt vmcnt(4)
  s_waitcnt lgkmcnt(13)
  v_mfma_f32_32x32x16_bf16 v[72:87], v[64:67], v[132:135], v[72:87]
  ds_read_b64_tr_b16 v[56:57], v37 offset:53248
  ds_read_b64_tr_b16 v[58:59], v37 offset:53760
  s_waitcnt lgkmcnt(13)
  v_mfma_f32_32x32x16_bf16 v[88:103], v[68:71], v[132:135], v[88:103]
  ds_read_b64_tr_b16 v[60:61], v38 offset:53248
  ds_read_b64_tr_b16 v[62:63], v38 offset:53760
  ds_read_b128 v[188:191], v39 offset:80
  s_waitcnt vmcnt(3)
  s_waitcnt lgkmcnt(13)
  v_mfma_f32_32x32x16_bf16 v[72:87], v[40:43], v[136:139], v[72:87]
  ds_read_b64_tr_b16 v[64:65], v37 offset:55296
  ds_read_b64_tr_b16 v[66:67], v37 offset:55808
  s_waitcnt lgkmcnt(13)
  v_mfma_f32_32x32x16_bf16 v[88:103], v[44:47], v[136:139], v[88:103]
  ds_read_b64_tr_b16 v[68:69], v38 offset:55296
  ds_read_b64_tr_b16 v[70:71], v38 offset:55808
  s_barrier
  ds_read_b128 v[192:195], v39 offset:96
  s_waitcnt vmcnt(2)
  s_waitcnt lgkmcnt(13)
  v_mfma_f32_32x32x16_bf16 v[72:87], v[48:51], v[140:143], v[72:87]
  s_waitcnt lgkmcnt(11)
  v_mfma_f32_32x32x16_bf16 v[88:103], v[52:55], v[140:143], v[88:103]
  ds_read_b128 v[196:199], v39 offset:112
  s_waitcnt vmcnt(1)
  s_waitcnt lgkmcnt(9)
  v_mfma_f32_32x32x16_bf16 v[72:87], v[56:59], v[144:147], v[72:87]
  s_waitcnt lgkmcnt(7)
  v_mfma_f32_32x32x16_bf16 v[88:103], v[60:63], v[144:147], v[88:103]
  s_waitcnt vmcnt(0)
  s_waitcnt lgkmcnt(4)
  v_mfma_f32_32x32x16_bf16 v[72:87], v[64:67], v[148:151], v[72:87]
  s_waitcnt lgkmcnt(2)
  v_mfma_f32_32x32x16_bf16 v[88:103], v[68:71], v[148:151], v[88:103]
  s_nop 9
  v_pk_fma_f32 v[72:73], v[72:73], v[168:169], v[216:217]
  v_pk_fma_f32 v[74:75], v[74:75], v[170:171], v[218:219]
  v_pk_fma_f32 v[76:77], v[76:77], v[172:173], v[220:221]
  v_pk_fma_f32 v[78:79], v[78:79], v[174:175], v[222:223]
  v_pk_fma_f32 v[80:81], v[80:81], v[176:177], v[224:225]
  v_pk_fma_f32 v[82:83], v[82:83], v[178:179], v[226:227]
  v_pk_fma_f32 v[84:85], v[84:85], v[180:181], v[228:229]
  v_pk_fma_f32 v[86:87], v[86:87], v[182:183], v[230:231]
  v_pk_fma_f32 v[88:89], v[88:89], v[184:185], v[232:233]
  v_pk_fma_f32 v[90:91], v[90:91], v[186:187], v[234:235]
  v_pk_fma_f32 v[92:93], v[92:93], v[188:189], v[236:237]
  v_pk_fma_f32 v[94:95], v[94:95], v[190:191], v[238:239]
  s_waitcnt lgkmcnt(1)
  v_pk_fma_f32 v[96:97], v[96:97], v[192:193], v[240:241]
  v_pk_fma_f32 v[98:99], v[98:99], v[194:195], v[242:243]
  s_waitcnt lgkmcnt(0)
  v_pk_fma_f32 v[100:101], v[100:101], v[196:197], v[244:245]
  v_pk_fma_f32 v[102:103], v[102:103], v[198:199], v[246:247]
  v_pk_add_f32 v[48:49], v[72:73], v[74:75]
  v_pk_mul_f32 v[50:51], v[72:73], v[72:73]
  v_pk_fma_f32 v[50:51], v[74:75], v[74:75], v[50:51]
  v_pk_add_f32 v[48:49], v[48:49], v[76:77]
  v_pk_fma_f32 v[50:51], v[76:77], v[76:77], v[50:51]
  v_pk_add_f32 v[48:49], v[48:49], v[78:79]
  v_pk_fma_f32 v[50:51], v[78:79], v[78:79], v[50:51]
  v_pk_add_f32 v[48:49], v[48:49], v[80:81]
  v_pk_fma_f32 v[50:51], v[80:81], v[80:81], v[50:51]
  v_pk_add_f32 v[48:49], v[48:49], v[82:83]
  v_pk_fma_f32 v[50:51], v[82:83], v[82:83], v[50:51]
  v_pk_add_f32 v[48:49], v[48:49], v[84:85]
  v_pk_fma_f32 v[50:51], v[84:85], v[84:85], v[50:51]
  v_pk_add_f32 v[48:49], v[48:49], v[86:87]
  v_pk_fma_f32 v[50:51], v[86:87], v[86:87], v[50:51]
  v_pk_add_f32 v[48:49], v[48:49], v[88:89]
  v_pk_fma_f32 v[50:51], v[88:89], v[88:89], v[50:51]
  v_pk_add_f32 v[48:49], v[48:49], v[90:91]
  v_pk_fma_f32 v[50:51], v[90:91], v[90:91], v[50:51]
  v_pk_add_f32 v[48:49], v[48:49], v[92:93]
  v_pk_fma_f32 v[50:51], v[92:93], v[92:93], v[50:51]
  v_pk_add_f32 v[48:49], v[48:49], v[94:95]
  v_pk_fma_f32 v[50:51], v[94:95], v[94:95], v[50:51]
  v_pk_add_f32 v[48:49], v[48:49], v[96:97]
  v_pk_fma_f32 v[50:51], v[96:97], v[96:97], v[50:51]
  v_pk_add_f32 v[48:49], v[48:49], v[98:99]
  v_pk_fma_f32 v[50:51], v[98:99], v[98:99], v[50:51]
  v_pk_add_f32 v[48:49], v[48:49], v[100:101]
  v_pk_fma_f32 v[50:51], v[100:101], v[100:101], v[50:51]
  v_pk_add_f32 v[48:49], v[48:49], v[102:103]
  v_pk_fma_f32 v[50:51], v[102:103], v[102:103], v[50:51]
  v_add_f32 v48, v48, v49
  v_add_f32 v49, v50, v51
  v_mov_b32 v50, v48
  v_mov_b32 v51, v49
  s_nop 0
  v_permlane32_swap_b32 v48, v50
  v_permlane32_swap_b32 v49, v51
  v_pk_add_f32 v[48:49], v[48:49], v[50:51]
  v_or_b32 v48, 1, v48
  v_or_b32 v49, 1, v49
  s_cmp_lg_u32 s55, 0
  s_cbranch_scc1 adaLN_cond__sliding_local_dilated__glu_gated_geglu__prompt_kernel_m128
  s_mov_b32 exec_hi, 0
  buffer_store_dwordx2 v[48:49], v15, s[44:47], s90 offen
  s_mov_b32 exec_hi, -1
adaLN_cond__sliding_local_dilated__glu_gated_geglu__prompt_kernel_e129:
  v_cvt_pk_bf16_f32 v200, v72, v73
  v_cvt_pk_bf16_f32 v201, v74, v75
  v_cvt_pk_bf16_f32 v202, v76, v77
  v_cvt_pk_bf16_f32 v203, v78, v79
  v_cvt_pk_bf16_f32 v204, v80, v81
  v_cvt_pk_bf16_f32 v205, v82, v83
  v_cvt_pk_bf16_f32 v206, v84, v85
  v_cvt_pk_bf16_f32 v207, v86, v87
  v_cvt_pk_bf16_f32 v208, v88, v89
  v_cvt_pk_bf16_f32 v209, v90, v91
  v_cvt_pk_bf16_f32 v210, v92, v93
  v_cvt_pk_bf16_f32 v211, v94, v95
  v_cvt_pk_bf16_f32 v212, v96, v97
  v_cvt_pk_bf16_f32 v213, v98, v99
  v_cvt_pk_bf16_f32 v214, v100, v101
  v_cvt_pk_bf16_f32 v215, v102, v103
  v_lshl_add_u32 v15, v9, 10, v15
  v_mov_b32 v46, 1
  v_mov_b32 v47, 1
  ds_read_b128 v[136:139], v39 offset:512
  ds_read_b128 v[140:143], v39 offset:528
  ds_read_b128 v[144:147], v39 offset:544
  ds_read_b128 v[148:151], v39 offset:560
  ds_read_b128 v[152:155], v39 offset:576
  ds_read_b128 v[156:159], v39 offset:592
  ds_read_b128 v[160:163], v39 offset:608
  ds_read_b128 v[164:167], v39 offset:624
  ds_read_b128 v[104:107], v39 offset:256
  ds_read_b128 v[108:111], v39 offset:272
  ds_read_b128 v[112:115], v39 offset:288
  ds_read_b128 v[116:119], v39 offset:304
  ds_read_b128 v[120:123], v39 offset:320
  ds_read_b128 v[124:127], v39 offset:336
  ds_read_b128 v[128:131], v39 offset:352
  ds_read_b128 v[132:135], v39 offset:368
  s_mov_b32 s99, 262144
adaLN_cond__sliding_local_dilated__glu_gated_geglu__prompt_kernel_p130:
  buffer_load_dwordx2 v[40:41], v15, s[44:47], s91 offen offset:0 sc1
  buffer_load_dwordx2 v[42:43], v15, s[44:47], s91 offen offset:256 sc1
  buffer_load_dwordx2 v[44:45], v15, s[44:47], s91 offen offset:512 sc1
  s_mov_b32 exec_hi, 0
  buffer_load_dwordx2 v[46:47], v15, s[44:47], s91 offen offset:768 sc1
  s_mov_b32 exec_hi, -1
  s_waitcnt vmcnt(0)
  v_bitop3_b32 v8, v4, v40, v41 bitop3:0x80
  v_bitop3_b32 v3, v42, v43, v44 bitop3:0x80
  v_bitop3_b32 v8, v8, v45, v46 bitop3:0x80
  v_bitop3_b32 v8, v8, v3, v47 bitop3:0x80
  v_cmp_ne_u32 vcc, 1, v8
  s_sub_u32 s99, s99, 1
  s_cbranch_scc1 adaLN_cond__sliding_local_dilated__glu_gated_geglu__prompt_kernel_d131
  s_cbranch_vccnz adaLN_cond__sliding_local_dilated__glu_gated_geglu__prompt_kernel_p130
adaLN_cond__sliding_local_dilated__glu_gated_geglu__prompt_kernel_d131:
  v_pk_add_f32 v[40:41], v[40:41], v[42:43]
  v_pk_add_f32 v[44:45], v[44:45], v[46:47]
  v_pk_add_f32 v[40:41], v[40:41], v[44:45]
  v_mov_b32 v42, v40
  v_mov_b32 v43, v41
  s_mov_b32 s88, 0x3b124925
  s_mov_b32 s89, 0x3b124925
  v_permlane32_swap_b32 v40, v42
  v_permlane32_swap_b32 v41, v43
  v_pk_add_f32 v[40:41], v[40:41], v[42:43]
  v_pk_mul_f32 v[40:41], v[40:41], s[88:89]
  v_fma_f32 v41, -v40, v40, v41
  v_max_f32 v41, 0, v41
  v_add_f32 v41, 0x3727c5ac, v41
  v_rsq_f32 v42, v41
  s_nop 0
  v_mul_f32 v44, v40, v42
  v_pk_fma_f32 v[72:73], v[72:73], v[42:43], v[44:45] op_sel_hi:[1,0,0] neg_lo:[0,0,1] neg_hi:[0,0,1]
  v_pk_fma_f32 v[74:75], v[74:75], v[42:43], v[44:45] op_sel_hi:[1,0,0] neg_lo:[0,0,1] neg_hi:[0,0,1]
  v_pk_fma_f32 v[76:77], v[76:77], v[42:43], v[44:45] op_sel_hi:[1,0,0] neg_lo:[0,0,1] neg_hi:[0,0,1]
  v_pk_fma_f32 v[78:79], v[78:79], v[42:43], v[44:45] op_sel_hi:[1,0,0] neg_lo:[0,0,1] neg_hi:[0,0,1]
  s_waitcnt lgkmcnt(7)
  v_pk_fma_f32 v[72:73], v[72:73], v[136:137], v[104:105]
  v_pk_fma_f32 v[74:75], v[74:75], v[138:139], v[106:107]
  s_waitcnt lgkmcnt(6)
  v_pk_fma_f32 v[76:77], v[76:77], v[140:141], v[108:109]
  v_pk_fma_f32 v[78:79], v[78:79], v[142:143], v[110:111]
  v_cvt_pk_bf16_f32 v56, v72, v73
  v_cvt_pk_bf16_f32 v57, v74, v75
  v_cvt_pk_bf16_f32 v58, v76, v77
  v_cvt_pk_bf16_f32 v59, v78, v79
  s_cmp_lg_u32 s55, 0
  s_cbranch_scc1 adaLN_cond__sliding_local_dilated__glu_gated_geglu__prompt_kernel_m132
  buffer_store_dwordx4 v[56:59], v2, s[44:47], s95 offen offset:0
adaLN_cond__sliding_local_dilated__glu_gated_geglu__prompt_kernel_e133:
  v_pk_fma_f32 v[80:81], v[80:81], v[42:43], v[44:45] op_sel_hi:[1,0,0] neg_lo:[0,0,1] neg_hi:[0,0,1]
  v_pk_fma_f32 v[82:83], v[82:83], v[42:43], v[44:45] op_sel_hi:[1,0,0] neg_lo:[0,0,1] neg_hi:[0,0,1]
  v_pk_fma_f32 v[84:85], v[84:85], v[42:43], v[44:45] op_sel_hi:[1,0,0] neg_lo:[0,0,1] neg_hi:[0,0,1]
  v_pk_fma_f32 v[86:87], v[86:87], v[42:43], v[44:45] op_sel_hi:[1,0,0] neg_lo:[0,0,1] neg_hi:[0,0,1]
  s_waitcnt lgkmcnt(5)
  v_pk_fma_f32 v[80:81], v[80:81], v[144:145], v[112:113]
  v_pk_fma_f32 v[82:83], v[82:83], v[146:147], v[114:115]
  s_waitcnt lgkmcnt(4)
  v_pk_fma_f32 v[84:85], v[84:85], v[148:149], v[116:117]
  v_pk_fma_f32 v[86:87], v[86:87], v[150:151], v[118:119]
  v_cvt_pk_bf16_f32 v60, v80, v81
  v_cvt_pk_bf16_f32 v61, v82, v83
  v_cvt_pk_bf16_f32 v62, v84, v85
  v_cvt_pk_bf16_f32 v63, v86, v87
  s_cmp_lg_u32 s55, 0
  s_cbranch_scc1 adaLN_cond__sliding_local_dilated__glu_gated_geglu__prompt_kernel_m134
  buffer_store_dwordx4 v[60:63], v2, s[44:47], s95 offen offset:1024
adaLN_cond__sliding_local_dilated__glu_gated_geglu__prompt_kernel_e135:
  v_pk_fma_f32 v[88:89], v[88:89], v[42:43], v[44:45] op_sel_hi:[1,0,0] neg_lo:[0,0,1] neg_hi:[0,0,1]
  v_pk_fma_f32 v[90:91], v[90:91], v[42:43], v[44:45] op_sel_hi:[1,0,0] neg_lo:[0,0,1] neg_hi:[0,0,1]
  v_pk_fma_f32 v[92:93], v[92:93], v[42:43], v[44:45] op_sel_hi:[1,0,0] neg_lo:[0,0,1] neg_hi:[0,0,1]
  v_pk_fma_f32 v[94:95], v[94:95], v[42:43], v[44:45] op_sel_hi:[1,0,0] neg_lo:[0,0,1] neg_hi:[0,0,1]
  s_waitcnt lgkmcnt(3)
  v_pk_fma_f32 v[88:89], v[88:89], v[152:153], v[120:121]
  v_pk_fma_f32 v[90:91], v[90:91], v[154:155], v[122:123]
  s_waitcnt lgkmcnt(2)
  v_pk_fma_f32 v[92:93], v[92:93], v[156:157], v[124:125]
  v_pk_fma_f32 v[94:95], v[94:95], v[158:159], v[126:127]
  v_cvt_pk_bf16_f32 v64, v88, v89
  v_cvt_pk_bf16_f32 v65, v90, v91
  v_cvt_pk_bf16_f32 v66, v92, v93
  v_cvt_pk_bf16_f32 v67, v94, v95
  s_cmp_lg_u32 s55, 0
  s_cbranch_scc1 adaLN_cond__sliding_local_dilated__glu_gated_geglu__prompt_kernel_m136
  buffer_store_dwordx4 v[64:67], v2, s[44:47], s95 offen offset:2048
adaLN_cond__sliding_local_dilated__glu_gated_geglu__prompt_kernel_e137:
  v_pk_fma_f32 v[96:97], v[96:97], v[42:43], v[44:45] op_sel_hi:[1,0,0] neg_lo:[0,0,1] neg_hi:[0,0,1]
  v_pk_fma_f32 v[98:99], v[98:99], v[42:43], v[44:45] op_sel_hi:[1,0,0] neg_lo:[0,0,1] neg_hi:[0,0,1]
  v_pk_fma_f32 v[100:101], v[100:101], v[42:43], v[44:45] op_sel_hi:[1,0,0] neg_lo:[0,0,1] neg_hi:[0,0,1]
  v_pk_fma_f32 v[102:103], v[102:103], v[42:43], v[44:45] op_sel_hi:[1,0,0] neg_lo:[0,0,1] neg_hi:[0,0,1]
  s_waitcnt lgkmcnt(1)
  v_pk_fma_f32 v[96:97], v[96:97], v[160:161], v[128:129]
  v_pk_fma_f32 v[98:99], v[98:99], v[162:163], v[130:131]
  s_waitcnt lgkmcnt(0)
  v_pk_fma_f32 v[100:101], v[100:101], v[164:165], v[132:133]
  v_pk_fma_f32 v[102:103], v[102:103], v[166:167], v[134:135]
  v_cvt_pk_bf16_f32 v68, v96, v97
  v_cvt_pk_bf16_f32 v69, v98, v99
  v_cvt_pk_bf16_f32 v70, v100, v101
  v_cvt_pk_bf16_f32 v71, v102, v103
  s_cmp_lg_u32 s55, 0
  s_cbranch_scc1 adaLN_cond__sliding_local_dilated__glu_gated_geglu__prompt_kernel_m138
  buffer_store_dwordx4 v[68:71], v2, s[44:47], s95 offen offset:3072
  s_waitcnt vmcnt(0)
  s_mov_b64 exec, 1
  buffer_store_dword v4, off, s[44:47], s94
  s_mov_b64 exec, -1
adaLN_cond__sliding_local_dilated__glu_gated_geglu__prompt_kernel_e139:
  s_add_u32 s91, s94, 32
  s_cmp_lg_u32 s55, 0
  s_cbranch_scc1 adaLN_cond__sliding_local_dilated__glu_gated_geglu__prompt_kernel_m140
  buffer_store_dwordx4 v[200:203], v2, s[44:47], s97 offen offset:0
  buffer_store_dwordx4 v[204:207], v2, s[44:47], s97 offen offset:1024
  buffer_store_dwordx4 v[208:211], v2, s[44:47], s97 offen offset:2048
  buffer_store_dwordx4 v[212:215], v2, s[44:47], s97 offen offset:3072
adaLN_cond__sliding_local_dilated__glu_gated_geglu__prompt_kernel_e141:
  s_cmp_lt_u32 s50, 28
  s_cbranch_scc1 L_p3x
  s_cmp_lg_u32 s55, 0
  s_cbranch_scc1 adaLN_cond__sliding_local_dilated__glu_gated_geglu__prompt_kernel_m142
  s_waitcnt vmcnt(0)
  s_mov_b64 exec, 1
  buffer_store_dword v4, off, s[44:47], s91
  s_mov_b64 exec, -1
adaLN_cond__sliding_local_dilated__glu_gated_geglu__prompt_kernel_e143:
L_sp0:
  s_barrier
  s_sub_u32 s91, s50, 28
  s_lshl_b32 s91, s91, 2
  s_add_u32 s91, s91, s52
  s_sub_u32 s91, s91, 4
  s_cmp_lg_u32 s91, 0
  s_cbranch_scc1 L_nomark
  s_add_u32 s88, s56, 1536
  v_min_u32 v3, 63, v1
  v_lshlrev_b32 v3, 2, v3
  s_mov_b32 s99, 262144
adaLN_cond__sliding_local_dilated__glu_gated_geglu__prompt_kernel_p144:
  buffer_load_dword v8, v3, s[44:47], s88 offen sc1
  s_waitcnt vmcnt(0)
  v_cmp_ne_u32 vcc, 1, v8
  s_sub_u32 s99, s99, 1
  s_cbranch_scc1 adaLN_cond__sliding_local_dilated__glu_gated_geglu__prompt_kernel_d145
  s_cbranch_vccnz adaLN_cond__sliding_local_dilated__glu_gated_geglu__prompt_kernel_p144
adaLN_cond__sliding_local_dilated__glu_gated_geglu__prompt_kernel_d145:
  s_add_u32 s88, s56, 1792
  v_min_u32 v3, 63, v1
  v_lshlrev_b32 v3, 2, v3
  s_mov_b32 s99, 262144
adaLN_cond__sliding_local_dilated__glu_gated_geglu__prompt_kernel_p146:
  buffer_load_dword v8, v3, s[44:47], s88 offen sc1
  s_waitcnt vmcnt(0)
  v_cmp_ne_u32 vcc, 1, v8
  s_sub_u32 s99, s99, 1
  s_cbranch_scc1 adaLN_cond__sliding_local_dilated__glu_gated_geglu__prompt_kernel_d147
  s_cbranch_vccnz adaLN_cond__sliding_local_dilated__glu_gated_geglu__prompt_kernel_p146
adaLN_cond__sliding_local_dilated__glu_gated_geglu__prompt_kernel_d147:
  v_mov_b32 v15, s81
  s_lshl_b32 s88, s53, 2
  s_add_u32 s88, s88, 344192
  s_mov_b64 exec, 1
  buffer_store_dword v15, off, s[44:47], s88 sc1
  s_mov_b64 exec, -1
L_nomark:
  s_cmp_lt_u32 s91, 8
  s_cbranch_scc1 L_nidle
  s_sub_u32 s90, s91, 8
  s_mul_i32 s88, s90, 25088
  s_add_u32 s88, s88, 0
  s_mul_i32 s89, s53, 200704
  s_add_u32 s88, s88, s89
  buffer_load_dword v255, v17, s[24:27], s88 offen
  s_add_u32 s88, s88, 8192
  buffer_load_dword v255, v17, s[24:27], s88 offen
  s_add_u32 s88, s88, 8192
  buffer_load_dword v255, v17, s[24:27], s88 offen
  s_add_u32 s88, s88, 8192
  s_mov_b32 exec_lo, 15
  s_mov_b32 exec_hi, 0
  buffer_load_dword v255, v17, s[24:27], s88 offen
  s_mov_b64 exec, -1
  s_add_u32 s88, s56, 2048
  v_min_u32 v3, 6, v1
  v_lshlrev_b32 v3, 2, v3
  s_mov_b32 s99, 262144
adaLN_cond__sliding_local_dilated__glu_gated_geglu__prompt_kernel_p148:
  buffer_load_dword v8, v3, s[44:47], s88 offen sc1
  s_waitcnt vmcnt(0)
  v_cmp_ne_u32 vcc, 1, v8
  s_nop 0
  s_cbranch_vccz adaLN_cond__sliding_local_dilated__glu_gated_geglu__prompt_kernel_d149
  s_sleep 8
  s_sub_u32 s99, s99, 1
  s_cbranch_scc1 adaLN_cond__sliding_local_dilated__glu_gated_geglu__prompt_kernel_d149
  s_cbranch_vccnz adaLN_cond__sliding_local_dilated__glu_gated_geglu__prompt_kernel_p148
adaLN_cond__sliding_local_dilated__glu_gated_geglu__prompt_kernel_d149:
L_nidle:
  s_lshr_b32 s90, s91, 2
  s_mul_i32 s90, s90, 401408
  s_and_b32 s89, s91, 3
  s_mul_i32 s89, s89, 8192
  s_add_u32 s90, s90, s89
  buffer_load_dword v255, v17, s[24:27], s90 offen
  s_add_u32 s90, s90, 32768
  buffer_load_dword v255, v17, s[24:27], s90 offen
  s_add_u32 s90, s90, 32768
  buffer_load_dword v255, v17, s[24:27], s90 offen
  s_add_u32 s90, s90, 32768
  buffer_load_dword v255, v17, s[24:27], s90 offen
  s_add_u32 s90, s90, 32768
  buffer_load_dword v255, v17, s[24:27], s90 offen
  s_add_u32 s90, s90, 32768
  buffer_load_dword v255, v17, s[24:27], s90 offen
  s_add_u32 s90, s90, 32768
  buffer_load_dword v255, v17, s[24:27], s90 offen
  s_add_u32 s90, s90, 32768
  buffer_load_dword v255, v17, s[24:27], s90 offen
  s_add_u32 s90, s90, 32768
  buffer_load_dword v255, v17, s[24:27], s90 offen
  s_add_u32 s90, s90, 32768
  buffer_load_dword v255, v17, s[24:27], s90 offen
  s_add_u32 s90, s90, 32768
  buffer_load_dword v255, v17, s[24:27], s90 offen
  s_add_u32 s90, s90, 32768
  buffer_load_dword v255, v17, s[24:27], s90 offen
  s_add_u32 s90, s90, 32768
  buffer_load_dword v255, v17, s[24:27], s90 offen
  s_add_u32 s90, s90, 32768
  s_lshl_b32 s88, s53, 4
  s_or_b32 s88, s88, s91
  s_cmp_lg_u32 s88, 0
  s_cbranch_scc1 L_fin
  s_mov_b32 s88, 344192
  v_min_u32 v3, 7, v1
  v_lshlrev_b32 v3, 2, v3
  s_mov_b32 s99, 262144
adaLN_cond__sliding_local_dilated__glu_gated_geglu__prompt_kernel_p150:
  buffer_load_dword v8, v3, s[44:47], s88 offen sc1
  s_waitcnt vmcnt(0)
  v_cmp_ne_u32 vcc, s81, v8
  s_sub_u32 s99, s99, 1
  s_cbranch_scc1 adaLN_cond__sliding_local_dilated__glu_gated_geglu__prompt_kernel_d151
  s_cbranch_vccnz adaLN_cond__sliding_local_dilated__glu_gated_geglu__prompt_kernel_p150
adaLN_cond__sliding_local_dilated__glu_gated_geglu__prompt_kernel_d151:
  v_mov_b32 v15, s81
  s_mov_b32 s88, 344064
  s_mov_b64 exec, 1
  buffer_store_dword v15, off, s[44:47], s88 sc1
  s_mov_b64 exec, -1
  s_branch L_fin
adaLN_cond__sliding_local_dilated__glu_gated_geglu__prompt_kernel_m11:
  s_waitcnt vmcnt(0)
  s_mov_b64 exec, 1
  buffer_store_dword v4, off, s[44:47], s88 sc1
  s_mov_b64 exec, -1
  s_nop 1
  s_branch adaLN_cond__sliding_local_dilated__glu_gated_geglu__prompt_kernel_e12
adaLN_cond__sliding_local_dilated__glu_gated_geglu__prompt_kernel_sl14:
  s_sleep 2
  s_sub_u32 s99, s99, 1
  s_cmp_lg_u32 s99, 0
  s_cbranch_scc1 adaLN_cond__sliding_local_dilated__glu_gated_geglu__prompt_kernel_cp13
  v_mov_b32 v8, s3
  s_mov_b64 exec, 1
  buffer_store_byte v8, off, s[40:43], s86 sc1
  s_mov_b64 exec, -1
  s_mov_b32 s99, 262144
adaLN_cond__sliding_local_dilated__glu_gated_geglu__prompt_kernel_sp15:
  s_sleep 16
  buffer_load_ubyte v8, v3, s[40:43], s87 offen sc1
  s_waitcnt vmcnt(0)
  v_cmp_eq_u32 vcc, 0, v8
  s_sub_u32 s99, s99, 1
  s_cbranch_vccz adaLN_cond__sliding_local_dilated__glu_gated_geglu__prompt_kernel_sd16
  s_cmp_lg_u32 s99, 0
  s_cbranch_scc1 adaLN_cond__sliding_local_dilated__glu_gated_geglu__prompt_kernel_sp15
adaLN_cond__sliding_local_dilated__glu_gated_geglu__prompt_kernel_sd16:
  s_mov_b32 s98, 2
  s_branch adaLN_cond__sliding_local_dilated__glu_gated_geglu__prompt_kernel_wr17
adaLN_cond__sliding_local_dilated__glu_gated_geglu__prompt_kernel_sl19:
  s_sleep 2
  s_sub_u32 s99, s99, 1
  s_cmp_lg_u32 s99, 0
  s_cbranch_scc1 adaLN_cond__sliding_local_dilated__glu_gated_geglu__prompt_kernel_cp18
  v_mov_b32 v8, s3
  s_mov_b64 exec, 1
  buffer_store_byte v8, off, s[40:43], s86 sc1
  s_mov_b64 exec, -1
  s_mov_b32 s99, 262144
adaLN_cond__sliding_local_dilated__glu_gated_geglu__prompt_kernel_sp20:
  s_sleep 16
  buffer_load_ubyte v8, v3, s[40:43], s87 offen sc1
  s_waitcnt vmcnt(0)
  v_cmp_eq_u32 vcc, 0, v8
  s_sub_u32 s99, s99, 1
  s_cbranch_vccz adaLN_cond__sliding_local_dilated__glu_gated_geglu__prompt_kernel_sd21
  s_cmp_lg_u32 s99, 0
  s_cbranch_scc1 adaLN_cond__sliding_local_dilated__glu_gated_geglu__prompt_kernel_sp20
adaLN_cond__sliding_local_dilated__glu_gated_geglu__prompt_kernel_sd21:
  s_mov_b32 s98, 2
  s_branch adaLN_cond__sliding_local_dilated__glu_gated_geglu__prompt_kernel_wr22
adaLN_cond__sliding_local_dilated__glu_gated_geglu__prompt_kernel_m29:
  buffer_store_dwordx4 v[40:43], v90, s[44:47], s94 offen sc1
  buffer_store_dwordx4 v[44:47], v90, s[44:47], s95 offen sc1
  buffer_store_dwordx4 v[48:51], v90, s[44:47], s96 offen sc1
  s_mov_b32 exec_hi, 0
  buffer_store_dwordx4 v[52:55], v90, s[44:47], s97 offen sc1
  s_waitcnt vmcnt(0)
  s_mov_b64 exec, 1
  buffer_store_dwordx4 v[4:7], off, s[44:47], s90 sc1
  s_mov_b64 exec, -1
  s_nop 1
  s_branch adaLN_cond__sliding_local_dilated__glu_gated_geglu__prompt_kernel_e30
adaLN_cond__sliding_local_dilated__glu_gated_geglu__prompt_kernel_g33:
  s_mov_b32 s99, 1048576
adaLN_cond__sliding_local_dilated__glu_gated_geglu__prompt_kernel_g33_l:
  ds_read_b64 v[20:21], v18 offset:8
  s_waitcnt lgkmcnt(0)
  v_min_u32 v20, v20, v21
  v_cmp_gt_u32 vcc, 2, v20
  s_sub_u32 s99, s99, 1
  s_cbranch_scc1 adaLN_cond__sliding_local_dilated__glu_gated_geglu__prompt_kernel_h34
  s_cbranch_vccnz adaLN_cond__sliding_local_dilated__glu_gated_geglu__prompt_kernel_g33_l
  s_branch adaLN_cond__sliding_local_dilated__glu_gated_geglu__prompt_kernel_h34
adaLN_cond__sliding_local_dilated__glu_gated_geglu__prompt_kernel_g35:
  s_mov_b32 s99, 1048576
adaLN_cond__sliding_local_dilated__glu_gated_geglu__prompt_kernel_g35_l:
  ds_read_b64 v[20:21], v18 offset:8
  s_waitcnt lgkmcnt(0)
  v_min_u32 v20, v20, v21
  v_cmp_gt_u32 vcc, 4, v20
  s_sub_u32 s99, s99, 1
  s_cbranch_scc1 adaLN_cond__sliding_local_dilated__glu_gated_geglu__prompt_kernel_h36
  s_cbranch_vccnz adaLN_cond__sliding_local_dilated__glu_gated_geglu__prompt_kernel_g35_l
  s_branch adaLN_cond__sliding_local_dilated__glu_gated_geglu__prompt_kernel_h36
adaLN_cond__sliding_local_dilated__glu_gated_geglu__prompt_kernel_g37:
  s_mov_b32 s99, 1048576
adaLN_cond__sliding_local_dilated__glu_gated_geglu__prompt_kernel_g37_l:
  ds_read_b64 v[20:21], v18 offset:8
  s_waitcnt lgkmcnt(0)
  v_min_u32 v20, v20, v21
  v_cmp_gt_u32 vcc, 6, v20
  s_sub_u32 s99, s99, 1
  s_cbranch_scc1 adaLN_cond__sliding_local_dilated__glu_gated_geglu__prompt_kernel_h38
  s_cbranch_vccnz adaLN_cond__sliding_local_dilated__glu_gated_geglu__prompt_kernel_g37_l
  s_branch adaLN_cond__sliding_local_dilated__glu_gated_geglu__prompt_kernel_h38
adaLN_cond__sliding_local_dilated__glu_gated_geglu__prompt_kernel_g39:
  s_mov_b32 s99, 1048576
adaLN_cond__sliding_local_dilated__glu_gated_geglu__prompt_kernel_g39_l:
  ds_read_b64 v[20:21], v18 offset:8
  s_waitcnt lgkmcnt(0)
  v_min_u32 v20, v20, v21
  v_cmp_gt_u32 vcc, 8, v20
  s_sub_u32 s99, s99, 1
  s_cbranch_scc1 adaLN_cond__sliding_local_dilated__glu_gated_geglu__prompt_kernel_h40
  s_cbranch_vccnz adaLN_cond__sliding_local_dilated__glu_gated_geglu__prompt_kernel_g39_l
  s_branch adaLN_cond__sliding_local_dilated__glu_gated_geglu__prompt_kernel_h40
adaLN_cond__sliding_local_dilated__glu_gated_geglu__prompt_kernel_g41:
  s_mov_b32 s99, 1048576
adaLN_cond__sliding_local_dilated__glu_gated_geglu__prompt_kernel_g41_l:
  ds_read_b64 v[20:21], v18 offset:8
  s_waitcnt lgkmcnt(0)
  v_min_u32 v20, v20, v21
  v_cmp_gt_u32 vcc, 10, v20
  s_sub_u32 s99, s99, 1
  s_cbranch_scc1 adaLN_cond__sliding_local_dilated__glu_gated_geglu__prompt_kernel_h42
  s_cbranch_vccnz adaLN_cond__sliding_local_dilated__glu_gated_geglu__prompt_kernel_g41_l
  s_branch adaLN_cond__sliding_local_dilated__glu_gated_geglu__prompt_kernel_h42
adaLN_cond__sliding_local_dilated__glu_gated_geglu__prompt_kernel_g43:
  s_mov_b32 s99, 1048576
adaLN_cond__sliding_local_dilated__glu_gated_geglu__prompt_kernel_g43_l:
  ds_read_b64 v[20:21], v18 offset:8
  s_waitcnt lgkmcnt(0)
  v_min_u32 v20, v20, v21
  v_cmp_gt_u32 vcc, 12, v20
  s_sub_u32 s99, s99, 1
  s_cbranch_scc1 adaLN_cond__sliding_local_dilated__glu_gated_geglu__prompt_kernel_h44
  s_cbranch_vccnz adaLN_cond__sliding_local_dilated__glu_gated_geglu__prompt_kernel_g43_l
  s_branch adaLN_cond__sliding_local_dilated__glu_gated_geglu__prompt_kernel_h44
adaLN_cond__sliding_local_dilated__glu_gated_geglu__prompt_kernel_g45:
  s_mov_b32 s99, 1048576
adaLN_cond__sliding_local_dilated__glu_gated_geglu__prompt_kernel_g45_l:
  ds_read_b64 v[20:21], v18 offset:8
  s_waitcnt lgkmcnt(0)
  v_min_u32 v20, v20, v21
  v_cmp_gt_u32 vcc, 14, v20
  s_sub_u32 s99, s99, 1
  s_cbranch_scc1 adaLN_cond__sliding_local_dilated__glu_gated_geglu__prompt_kernel_h46
  s_cbranch_vccnz adaLN_cond__sliding_local_dilated__glu_gated_geglu__prompt_kernel_g45_l
  s_branch adaLN_cond__sliding_local_dilated__glu_gated_geglu__prompt_kernel_h46
adaLN_cond__sliding_local_dilated__glu_gated_geglu__prompt_kernel_m47:
  buffer_store_dwordx2 v[184:185], v12, s[44:47], s89 offen offset:256 sc1
  buffer_store_dwordx2 v[176:177], v12, s[44:47], s89 offen offset:0 sc1
  s_mov_b32 exec_hi, 0xffff
  buffer_store_dwordx2 v[188:189], v12, s[44:47], s89 offen offset:1280 sc1
  buffer_store_dwordx2 v[180:181], v12, s[44:47], s89 offen offset:1024 sc1
  s_waitcnt vmcnt(0)
  s_mov_b64 exec, 1
  buffer_store_dword v4, off, s[44:47], s90 sc1
  s_mov_b64 exec, -1
  s_nop 1
  s_branch adaLN_cond__sliding_local_dilated__glu_gated_geglu__prompt_kernel_e48
adaLN_cond__sliding_local_dilated__glu_gated_geglu__prompt_kernel_m53:
  s_mov_b64 exec, 1
  buffer_store_dword v4, off, s[44:47], s91 sc1
  s_mov_b64 exec, -1
  s_nop 1
  s_branch adaLN_cond__sliding_local_dilated__glu_gated_geglu__prompt_kernel_e54
adaLN_cond__sliding_local_dilated__glu_gated_geglu__prompt_kernel_m55:
  s_waitcnt vmcnt(0)
  s_mov_b64 exec, 1
  buffer_store_dword v4, off, s[44:47], s94 sc1
  s_mov_b64 exec, -1
  s_nop 1
  s_branch adaLN_cond__sliding_local_dilated__glu_gated_geglu__prompt_kernel_e56
adaLN_cond__sliding_local_dilated__glu_gated_geglu__prompt_kernel_m76:
  s_mov_b32 exec_hi, 0
  buffer_store_dwordx4 v[200:203], v2, s[44:47], s88 offen sc1
  s_mov_b32 exec_hi, -1
  s_nop 1
  s_branch adaLN_cond__sliding_local_dilated__glu_gated_geglu__prompt_kernel_e77
adaLN_cond__sliding_local_dilated__glu_gated_geglu__prompt_kernel_g79:
  s_mov_b32 s99, 1048576
adaLN_cond__sliding_local_dilated__glu_gated_geglu__prompt_kernel_g79_l:
  ds_read_b64 v[20:21], v18 offset:8
  s_waitcnt lgkmcnt(0)
  v_min_u32 v20, v20, v21
  v_cmp_gt_u32 vcc, 1, v20
  s_sub_u32 s99, s99, 1
  s_cbranch_scc1 adaLN_cond__sliding_local_dilated__glu_gated_geglu__prompt_kernel_h80
  s_cbranch_vccnz adaLN_cond__sliding_local_dilated__glu_gated_geglu__prompt_kernel_g79_l
  s_branch adaLN_cond__sliding_local_dilated__glu_gated_geglu__prompt_kernel_h80
adaLN_cond__sliding_local_dilated__glu_gated_geglu__prompt_kernel_g90:
  s_mov_b32 s99, 1048576
adaLN_cond__sliding_local_dilated__glu_gated_geglu__prompt_kernel_g90_l:
  s_sleep 2
  ds_read_b64 v[20:21], v18 offset:8
  s_waitcnt lgkmcnt(0)
  v_min_u32 v20, v20, v21
  v_cmp_gt_u32 vcc, 1, v20
  s_sub_u32 s99, s99, 1
  s_cbranch_scc1 adaLN_cond__sliding_local_dilated__glu_gated_geglu__prompt_kernel_h91
  s_cbranch_vccnz adaLN_cond__sliding_local_dilated__glu_gated_geglu__prompt_kernel_g90_l
  s_branch adaLN_cond__sliding_local_dilated__glu_gated_geglu__prompt_kernel_h91
adaLN_cond__sliding_local_dilated__glu_gated_geglu__prompt_kernel_g92:
  s_mov_b32 s99, 1048576
adaLN_cond__sliding_local_dilated__glu_gated_geglu__prompt_kernel_g92_l:
  s_sleep 2
  ds_read_b64 v[20:21], v18 offset:8
  s_waitcnt lgkmcnt(0)
  v_min_u32 v20, v20, v21
  v_cmp_gt_u32 vcc, 3, v20
  s_sub_u32 s99, s99, 1
  s_cbranch_scc1 adaLN_cond__sliding_local_dilated__glu_gated_geglu__prompt_kernel_h93
  s_cbranch_vccnz adaLN_cond__sliding_local_dilated__glu_gated_geglu__prompt_kernel_g92_l
  s_branch adaLN_cond__sliding_local_dilated__glu_gated_geglu__prompt_kernel_h93
adaLN_cond__sliding_local_dilated__glu_gated_geglu__prompt_kernel_g94:
  s_mov_b32 s99, 1048576
adaLN_cond__sliding_local_dilated__glu_gated_geglu__prompt_kernel_g94_l:
  s_sleep 2
  ds_read_b64 v[20:21], v18 offset:8
  s_waitcnt lgkmcnt(0)
  v_min_u32 v20, v20, v21
  v_cmp_gt_u32 vcc, 5, v20
  s_sub_u32 s99, s99, 1
  s_cbranch_scc1 adaLN_cond__sliding_local_dilated__glu_gated_geglu__prompt_kernel_h95
  s_cbranch_vccnz adaLN_cond__sliding_local_dilated__glu_gated_geglu__prompt_kernel_g94_l
  s_branch adaLN_cond__sliding_local_dilated__glu_gated_geglu__prompt_kernel_h95
adaLN_cond__sliding_local_dilated__glu_gated_geglu__prompt_kernel_g96:
  s_mov_b32 s99, 1048576
adaLN_cond__sliding_local_dilated__glu_gated_geglu__prompt_kernel_g96_l:
  s_sleep 2
  ds_read_b64 v[20:21], v18 offset:8
  s_waitcnt lgkmcnt(0)
  v_min_u32 v20, v20, v21
  v_cmp_gt_u32 vcc, 7, v20
  s_sub_u32 s99, s99, 1
  s_cbranch_scc1 adaLN_cond__sliding_local_dilated__glu_gated_geglu__prompt_kernel_h97
  s_cbranch_vccnz adaLN_cond__sliding_local_dilated__glu_gated_geglu__prompt_kernel_g96_l
  s_branch adaLN_cond__sliding_local_dilated__glu_gated_geglu__prompt_kernel_h97
adaLN_cond__sliding_local_dilated__glu_gated_geglu__prompt_kernel_g98:
  s_mov_b32 s99, 1048576
adaLN_cond__sliding_local_dilated__glu_gated_geglu__prompt_kernel_g98_l:
  s_sleep 2
  ds_read_b64 v[20:21], v18 offset:8
  s_waitcnt lgkmcnt(0)
  v_min_u32 v20, v20, v21
  v_cmp_gt_u32 vcc, 9, v20
  s_sub_u32 s99, s99, 1
  s_cbranch_scc1 adaLN_cond__sliding_local_dilated__glu_gated_geglu__prompt_kernel_h99
  s_cbranch_vccnz adaLN_cond__sliding_local_dilated__glu_gated_geglu__prompt_kernel_g98_l
  s_branch adaLN_cond__sliding_local_dilated__glu_gated_geglu__prompt_kernel_h99
adaLN_cond__sliding_local_dilated__glu_gated_geglu__prompt_kernel_g100:
  s_mov_b32 s99, 1048576
adaLN_cond__sliding_local_dilated__glu_gated_geglu__prompt_kernel_g100_l:
  s_sleep 2
  ds_read_b64 v[20:21], v18 offset:8
  s_waitcnt lgkmcnt(0)
  v_min_u32 v20, v20, v21
  v_cmp_gt_u32 vcc, 11, v20
  s_sub_u32 s99, s99, 1
  s_cbranch_scc1 adaLN_cond__sliding_local_dilated__glu_gated_geglu__prompt_kernel_h101
  s_cbranch_vccnz adaLN_cond__sliding_local_dilated__glu_gated_geglu__prompt_kernel_g100_l
  s_branch adaLN_cond__sliding_local_dilated__glu_gated_geglu__prompt_kernel_h101
adaLN_cond__sliding_local_dilated__glu_gated_geglu__prompt_kernel_g102:
  s_mov_b32 s99, 1048576
adaLN_cond__sliding_local_dilated__glu_gated_geglu__prompt_kernel_g102_l:
  s_sleep 2
  ds_read_b64 v[20:21], v18 offset:8
  s_waitcnt lgkmcnt(0)
  v_min_u32 v20, v20, v21
  v_cmp_gt_u32 vcc, 13, v20
  s_sub_u32 s99, s99, 1
  s_cbranch_scc1 adaLN_cond__sliding_local_dilated__glu_gated_geglu__prompt_kernel_h103
  s_cbranch_vccnz adaLN_cond__sliding_local_dilated__glu_gated_geglu__prompt_kernel_g102_l
  s_branch adaLN_cond__sliding_local_dilated__glu_gated_geglu__prompt_kernel_h103
adaLN_cond__sliding_local_dilated__glu_gated_geglu__prompt_kernel_g104:
  s_mov_b32 s99, 1048576
adaLN_cond__sliding_local_dilated__glu_gated_geglu__prompt_kernel_g104_l:
  s_sleep 2
  ds_read_b64 v[20:21], v18 offset:8
  s_waitcnt lgkmcnt(0)
  v_min_u32 v20, v20, v21
  v_cmp_gt_u32 vcc, 2, v20
  s_sub_u32 s99, s99, 1
  s_cbranch_scc1 adaLN_cond__sliding_local_dilated__glu_gated_geglu__prompt_kernel_h105
  s_cbranch_vccnz adaLN_cond__sliding_local_dilated__glu_gated_geglu__prompt_kernel_g104_l
  s_branch adaLN_cond__sliding_local_dilated__glu_gated_geglu__prompt_kernel_h105
adaLN_cond__sliding_local_dilated__glu_gated_geglu__prompt_kernel_g106:
  s_mov_b32 s99, 1048576
adaLN_cond__sliding_local_dilated__glu_gated_geglu__prompt_kernel_g106_l:
  s_sleep 2
  ds_read_b64 v[20:21], v18 offset:8
  s_waitcnt lgkmcnt(0)
  v_min_u32 v20, v20, v21
  v_cmp_gt_u32 vcc, 4, v20
  s_sub_u32 s99, s99, 1
  s_cbranch_scc1 adaLN_cond__sliding_local_dilated__glu_gated_geglu__prompt_kernel_h107
  s_cbranch_vccnz adaLN_cond__sliding_local_dilated__glu_gated_geglu__prompt_kernel_g106_l
  s_branch adaLN_cond__sliding_local_dilated__glu_gated_geglu__prompt_kernel_h107
adaLN_cond__sliding_local_dilated__glu_gated_geglu__prompt_kernel_g108:
  s_mov_b32 s99, 1048576
adaLN_cond__sliding_local_dilated__glu_gated_geglu__prompt_kernel_g108_l:
  s_sleep 2
  ds_read_b64 v[20:21], v18 offset:8
  s_waitcnt lgkmcnt(0)
  v_min_u32 v20, v20, v21
  v_cmp_gt_u32 vcc, 6, v20
  s_sub_u32 s99, s99, 1
  s_cbranch_scc1 adaLN_cond__sliding_local_dilated__glu_gated_geglu__prompt_kernel_h109
  s_cbranch_vccnz adaLN_cond__sliding_local_dilated__glu_gated_geglu__prompt_kernel_g108_l
  s_branch adaLN_cond__sliding_local_dilated__glu_gated_geglu__prompt_kernel_h109
adaLN_cond__sliding_local_dilated__glu_gated_geglu__prompt_kernel_g110:
  s_mov_b32 s99, 1048576
adaLN_cond__sliding_local_dilated__glu_gated_geglu__prompt_kernel_g110_l:
  s_sleep 2
  ds_read_b64 v[20:21], v18 offset:8
  s_waitcnt lgkmcnt(0)
  v_min_u32 v20, v20, v21
  v_cmp_gt_u32 vcc, 8, v20
  s_sub_u32 s99, s99, 1
  s_cbranch_scc1 adaLN_cond__sliding_local_dilated__glu_gated_geglu__prompt_kernel_h111
  s_cbranch_vccnz adaLN_cond__sliding_local_dilated__glu_gated_geglu__prompt_kernel_g110_l
  s_branch adaLN_cond__sliding_local_dilated__glu_gated_geglu__prompt_kernel_h111
adaLN_cond__sliding_local_dilated__glu_gated_geglu__prompt_kernel_g112:
  s_mov_b32 s99, 1048576
adaLN_cond__sliding_local_dilated__glu_gated_geglu__prompt_kernel_g112_l:
  s_sleep 2
  ds_read_b64 v[20:21], v18 offset:8
  s_waitcnt lgkmcnt(0)
  v_min_u32 v20, v20, v21
  v_cmp_gt_u32 vcc, 10, v20
  s_sub_u32 s99, s99, 1
  s_cbranch_scc1 adaLN_cond__sliding_local_dilated__glu_gated_geglu__prompt_kernel_h113
  s_cbranch_vccnz adaLN_cond__sliding_local_dilated__glu_gated_geglu__prompt_kernel_g112_l
  s_branch adaLN_cond__sliding_local_dilated__glu_gated_geglu__prompt_kernel_h113
adaLN_cond__sliding_local_dilated__glu_gated_geglu__prompt_kernel_g114:
  s_mov_b32 s99, 1048576
adaLN_cond__sliding_local_dilated__glu_gated_geglu__prompt_kernel_g114_l:
  s_sleep 2
  ds_read_b64 v[20:21], v18 offset:8
  s_waitcnt lgkmcnt(0)
  v_min_u32 v20, v20, v21
  v_cmp_gt_u32 vcc, 12, v20
  s_sub_u32 s99, s99, 1
  s_cbranch_scc1 adaLN_cond__sliding_local_dilated__glu_gated_geglu__prompt_kernel_h115
  s_cbranch_vccnz adaLN_cond__sliding_local_dilated__glu_gated_geglu__prompt_kernel_g114_l
  s_branch adaLN_cond__sliding_local_dilated__glu_gated_geglu__prompt_kernel_h115
adaLN_cond__sliding_local_dilated__glu_gated_geglu__prompt_kernel_g116:
  s_mov_b32 s99, 1048576
adaLN_cond__sliding_local_dilated__glu_gated_geglu__prompt_kernel_g116_l:
  s_sleep 2
  ds_read_b64 v[20:21], v18 offset:8
  s_waitcnt lgkmcnt(0)
  v_min_u32 v20, v20, v21
  v_cmp_gt_u32 vcc, 14, v20
  s_sub_u32 s99, s99, 1
  s_cbranch_scc1 adaLN_cond__sliding_local_dilated__glu_gated_geglu__prompt_kernel_h117
  s_cbranch_vccnz adaLN_cond__sliding_local_dilated__glu_gated_geglu__prompt_kernel_g116_l
  s_branch adaLN_cond__sliding_local_dilated__glu_gated_geglu__prompt_kernel_h117
adaLN_cond__sliding_local_dilated__glu_gated_geglu__prompt_kernel_p121:
  v_lshrrev_b32 v12, 3, v1
  v_mul_u32_u24 v12, 896, v12
  v_and_b32 v13, 7, v1
  v_lshl_add_u32 v12, v13, 4, v12
  s_lshl_b32 s88, s82, 7
  s_add_u32 s88, s88, 331264
  buffer_load_dwordx4 v[100:103], v12, s[44:47], s88 offen sc1
  s_waitcnt vmcnt(0)
  s_sub_u32 s99, s99, 1
  s_cbranch_scc1 adaLN_cond__sliding_local_dilated__glu_gated_geglu__prompt_kernel_d122
  s_branch adaLN_cond__sliding_local_dilated__glu_gated_geglu__prompt_kernel_c123
adaLN_cond__sliding_local_dilated__glu_gated_geglu__prompt_kernel_m128:
  s_mov_b32 exec_hi, 0
  buffer_store_dwordx2 v[48:49], v15, s[44:47], s90 offen sc1
  s_mov_b32 exec_hi, -1
  s_nop 1
  s_branch adaLN_cond__sliding_local_dilated__glu_gated_geglu__prompt_kernel_e129
adaLN_cond__sliding_local_dilated__glu_gated_geglu__prompt_kernel_m132:
  buffer_store_dwordx4 v[56:59], v2, s[44:47], s95 offen offset:0 sc1
  s_nop 1
  s_branch adaLN_cond__sliding_local_dilated__glu_gated_geglu__prompt_kernel_e133
adaLN_cond__sliding_local_dilated__glu_gated_geglu__prompt_kernel_m134:
  buffer_store_dwordx4 v[60:63], v2, s[44:47], s95 offen offset:1024 sc1
  s_nop 1
  s_branch adaLN_cond__sliding_local_dilated__glu_gated_geglu__prompt_kernel_e135
adaLN_cond__sliding_local_dilated__glu_gated_geglu__prompt_kernel_m136:
  buffer_store_dwordx4 v[64:67], v2, s[44:47], s95 offen offset:2048 sc1
  s_nop 1
  s_branch adaLN_cond__sliding_local_dilated__glu_gated_geglu__prompt_kernel_e137
adaLN_cond__sliding_local_dilated__glu_gated_geglu__prompt_kernel_m138:
  buffer_store_dwordx4 v[68:71], v2, s[44:47], s95 offen offset:3072 sc1
  s_waitcnt vmcnt(0)
  s_mov_b64 exec, 1
  buffer_store_dword v4, off, s[44:47], s94 sc1
  s_mov_b64 exec, -1
  s_nop 1
  s_branch adaLN_cond__sliding_local_dilated__glu_gated_geglu__prompt_kernel_e139
adaLN_cond__sliding_local_dilated__glu_gated_geglu__prompt_kernel_m140:
  buffer_store_dwordx4 v[200:203], v2, s[44:47], s97 offen offset:0 sc1
  buffer_store_dwordx4 v[204:207], v2, s[44:47], s97 offen offset:1024 sc1
  buffer_store_dwordx4 v[208:211], v2, s[44:47], s97 offen offset:2048 sc1
  buffer_store_dwordx4 v[212:215], v2, s[44:47], s97 offen offset:3072 sc1
  s_nop 1
  s_branch adaLN_cond__sliding_local_dilated__glu_gated_geglu__prompt_kernel_e141
adaLN_cond__sliding_local_dilated__glu_gated_geglu__prompt_kernel_m142:
  s_waitcnt vmcnt(0)
  s_mov_b64 exec, 1
  buffer_store_dword v4, off, s[44:47], s91 sc1
  s_mov_b64 exec, -1
  s_nop 1
  s_branch adaLN_cond__sliding_local_dilated__glu_gated_geglu__prompt_kernel_e143
L_code_end:
  s_endpgm
.section .rodata,"a"
.p2align 6
.amdhsa_kernel adaLN_cond__sliding_local_dilated__glu_gated_geglu__prompt_kernel
  .amdhsa_next_free_vgpr 256
  .amdhsa_next_free_sgpr 100
  .amdhsa_accum_offset 256
  .amdhsa_group_segment_fixed_size 0
  .amdhsa_kernarg_size 96
  .amdhsa_user_sgpr_count 2
  .amdhsa_user_sgpr_kernarg_segment_ptr 1
  .amdhsa_system_sgpr_workgroup_id_x 1
.end_amdhsa_kernel
```
